```python
import torch

def _softmax(x, axis=-1):
    return torch.softmax(x, dim=axis)
def _gelu(x):
    return torch.nn.functional.gelu(x, approximate="tanh")
def _silu(x):
    return torch.nn.functional.silu(x)
def _sigmoid(x):
    return torch.sigmoid(x)
def _layernorm(x, axis=-1, eps=1e-5):
    m = x.mean(dim=axis, keepdim=True)
    v = x.var(dim=axis, keepdim=True, unbiased=False)
    return (x - m) / torch.sqrt(v + eps)
def _scatter_add(tgt, idx, src, axis=0):
    return tgt.clone().index_add_(axis, idx, src)
def _segment_sum(src, seg, n):
    out = torch.zeros((n,) + src.shape[1:], dtype=src.dtype)
    return out.index_add_(0, seg, src)
def _pad(x, pw):
    flat = tuple(v for pair in reversed(pw) for v in pair)
    return torch.nn.functional.pad(x, flat)

kernel_name = 'concat_heads__ssm_conv_h3__linear_attn_block__prompt'

def setup_inputs():

    _w = (lambda a: (lambda t: t.to(torch.bfloat16) if t.is_floating_point() else t)(torch.as_tensor(a)))
    def _A_setup():
        B, S, D = 1, 2048, 1024
        ks = 4
        return {
            "q": _w((lambda *s: torch.randn(*s, dtype=torch.bfloat16) * 0.05)(B, S, D)),
            "k": _w((lambda *s: torch.randn(*s, dtype=torch.bfloat16) * 0.4)(B, S, D)),
            "v": _w((lambda *s: torch.randn(*s, dtype=torch.bfloat16) * 0.4)(B, S, D)),
            "shift_k": _w((lambda *s: torch.randn(*s, dtype=torch.bfloat16) * 0.4)(D, ks) * 0.5),
            "ssm_k": _w((lambda *s: torch.randn(*s, dtype=torch.bfloat16) * 1.6)(D, S) * (1.0 / S ** 0.5)),
            "ssm_D": _w((lambda *s: torch.randn(*s, dtype=torch.bfloat16) * 0.4)(D)),
        }
    _A_in = _A_setup()

    def _B_setup():
        B, S, D = 1, 2048, 1024
        return {
            "x": _w((lambda *s: torch.randn(*s, dtype=torch.bfloat16) * 0.05)(B, S, D)),
            "wqkv": _w((lambda *s: torch.randn(*s, dtype=torch.bfloat16) * 0.8)(D, 3 * D)),
            "wo": _w((lambda *s: torch.randn(*s, dtype=torch.bfloat16) * 0.05)(D, D)),
        }
    _B_in = _B_setup()

    return {
        "A_q": _A_in["q"],
        "A_k": _A_in["k"],
        "A_v": _A_in["v"],
        "A_shift_k": _A_in["shift_k"],
        "A_ssm_k": _A_in["ssm_k"],
        "A_ssm_D": _A_in["ssm_D"],
        "B_x": _B_in["x"],
        "B_wqkv": _B_in["wqkv"],
        "B_wo": _B_in["wo"],
    }

def reference(A_q, A_k, A_v, A_shift_k, A_ssm_k, A_ssm_D, B_x, B_wqkv, B_wo):
    def _A_ref(q, k, v, shift_k, ssm_k, ssm_D):
        B, S, D = q.shape
        ks = shift_k.shape[-1]
        k_pad = _pad(k, ((0, 0), (ks - 1, 0), (0, 0)))
        k_shift = torch.zeros_like(k)
        for t in range(ks):
            k_shift = k_shift + k_pad[:, t:t + S, :] * shift_k[:, ks - 1 - t][None, None, :]
        kv = k_shift * v
        L = 2 * S
        kv_pad = _pad(kv, ((0, 0), (0, S), (0, 0)))
        kf_pad = _pad(ssm_k, ((0, 0), (0, S)))
        kv_f = (lambda x, axes=(-2,-1): torch.fft.rfft2(x.float(), dim=axes))(kv_pad[:, None, :, :], axes=(1, 2))
        kf_f = (lambda x, axes=(-2,-1): torch.fft.rfft2(x.float(), dim=axes))(kf_pad[:, None, :], axes=(1, 2))
        kf_f = (lambda x, *d: x.permute(*d))(kf_f, 1, 2, 0)
        y_f = kv_f * kf_f[None, :, :, :]
        y = (lambda x, s, axes=(-2,-1): torch.fft.irfft2(x, s=s, dim=axes).to(torch.bfloat16))(y_f, (1, L), axes=(1, 2))[:, 0, :S, :]
        y = y + kv * ssm_D[None, None, :]
        return q * y

    def _B_ref(x, wqkv, wo):
        B, S, D = x.shape
        H = 32; Dh = D // H
        qkv = (lambda x, *d: x.permute(*d))((x @ wqkv).reshape(B, S, 3, H, Dh), 2, 0, 3, 1, 4)
        q, k, v = qkv[0], qkv[1], qkv[2]
        phi = lambda t: torch.where(t > 0, t + 1, torch.exp(t)) + 1e-6
        pq, pk = phi(q), phi(k)
        kv = torch.einsum("bhsd,bhse->bhde", pk, v)
        z = torch.einsum("bhsd->bhd", pk)
        num = torch.einsum("bhqd,bhde->bhqe", pq, kv)
        den = torch.einsum("bhqd,bhd->bhq", pq, z)[..., None] + 1e-6
        o = num / den
        return (lambda x, *d: x.permute(*d))(o, 0, 2, 1, 3).reshape(B, S, D) @ wo

    a = _A_ref(A_q, A_k, A_v, A_shift_k, A_ssm_k, A_ssm_D)
    b = _B_ref(B_x, B_wqkv, B_wo)
    return torch.concatenate([a, b], axis=-1)
```

```asm
; @launch grid=(256,1,1) block=(512,1,1) lds=163840
.amdgcn_target "amdgcn-amd-amdhsa--gfx950"
.text
.globl concat_heads__ssm_conv_h3__linear_attn_block__prompt_kernel
.p2align 8
.type concat_heads__ssm_conv_h3__linear_attn_block__prompt_kernel,@function
concat_heads__ssm_conv_h3__linear_attn_block__prompt_kernel:

  s_cmp_ge_u32 s2, 256
  s_cbranch_scc1 L_end
  s_load_dwordx2 s[4:5], s[0:1], 48
  s_load_dwordx2 s[8:9], s[0:1], 56
  s_load_dwordx2 s[12:13], s[0:1], 88
  s_load_dwordx2 s[16:17], s[0:1], 8
  s_load_dwordx2 s[20:21], s[0:1], 16
  s_load_dwordx2 s[28:29], s[0:1], 32
  s_load_dwordx2 s[36:37], s[0:1], 64
  s_load_dwordx2 s[44:45], s[0:1], 0
  s_load_dwordx2 s[24:25], s[0:1], 24
  s_load_dwordx2 s[32:33], s[0:1], 40
  s_load_dwordx2 s[40:41], s[0:1], 72
  v_lshrrev_b32 v1, 6, v0
  s_and_b32 s56, s2, 7
  s_lshr_b32 s57, s2, 3
  v_readfirstlane_b32 s50, v1
  s_and_b32 s48, s56, 1
  s_lshl_b32 s48, s48, 3
  s_lshr_b32 s58, s56, 1
  s_xor_b32 s58, s58, 0
  s_lshl_b32 s49, s58, 2
  s_and_b32 s58, s57, 7
  s_or_b32 s48, s48, s58
  s_lshr_b32 s58, s57, 3
  s_xor_b32 s58, s58, 0
  s_or_b32 s49, s49, s58
  v_and_b32 v250, 63, v0
  s_lshl_b32 s54, s56, 1
  s_and_b32 s58, s57, 1
  s_or_b32 s54, s54, s58
  s_lshr_b32 s55, s2, 4
  s_mov_b32 s6, 4194304
  s_mov_b32 s7, 0x20000
  s_mov_b32 s10, 6291456
  s_mov_b32 s11, 0x20000
  s_mov_b32 s14, 16777216
  s_mov_b32 s15, 0x20000
  s_cmp_lt_u32 s50, 4
  s_cbranch_scc1 L_compute
L_hyb:
  s_sub_u32 s69, s50, 4
  v_lshrrev_b32 v24, 3, v250
  s_lshl_b32 s56, s48, 7
  s_lshl_b32 s57, s69, 5
  s_add_u32 s56, s56, s57
  v_add_u32 v25, s56, v24
  v_lshlrev_b32 v25, 11, v25
  v_lshrrev_b32 v26, 4, v250
  v_and_b32 v27, 7, v250
  v_xor_b32 v28, v26, v27
  v_xor_b32 v29, 4, v28
  v_lshl_add_u32 v28, v28, 4, v25
  v_lshl_add_u32 v29, v29, 4, v25
  v_mov_b32 v2, v28
  v_add_u32 v3, 15360, v29
  v_add_u32 v4, 30720, v28
  v_add_u32 v5, 46080, v29
  s_lshl_b32 s56, s69, 4
  v_add_u32 v25, s56, v24
  s_movk_i32 s57, 6144
  v_mul_lo_u32 v25, v25, s57
  v_and_b32 v26, 1, v26
  v_lshlrev_b32 v26, 2, v26
  v_xor_b32 v26, v26, v27
  v_lshl_add_u32 v25, v26, 4, v25
  s_xor_b32 s56, s49, 0
  s_lshl_b32 s56, s56, 7
  v_add_u32 v25, s56, v25
  v_add_u32 v6, 0, v25
  v_add_u32 v7, 48128, v25
  v_add_u32 v8, 2048, v25
  v_add_u32 v9, 50176, v25
  v_add_u32 v10, 4096, v25
  v_add_u32 v11, 52224, v25
  s_lshl_b32 s64, s69, 12
  s_lshl_b32 s65, s69, 11
  s_add_u32 s65, s65, 49152
  s_mov_b32 s68, 0
  s_add_u32 s70, s64, 49152
  s_and_b32 s56, s2, 7
  s_lshr_b32 s57, s56, 1
  s_lshl_b32 s57, s57, 2
  s_and_b32 s56, s56, 1
  s_lshl_b32 s56, s56, 3
  s_add_u32 s56, s56, s57
  s_and_b32 s56, s56, 15
  s_lshl_b32 s66, s56, 7
  s_mul_i32 s67, s56, 393216
  s_waitcnt lgkmcnt(0)
  s_load_dword s51, s[12:13], 0
  s_mov_b32 m0, s64
  s_add_u32 s64, s64, 16384
  buffer_load_dwordx4 v2, s[4:7], s66 offen offset:0 lds
  buffer_load_dwordx4 v3, s[4:7], s66 offen offset:1024 lds
  buffer_load_dwordx4 v4, s[4:7], s66 offen offset:2048 lds
  buffer_load_dwordx4 v5, s[4:7], s66 offen offset:3072 lds
  s_add_u32 m0, s65, 0
  s_add_u32 s66, s66, 128
  buffer_load_dwordx4 v6, s[8:11], s67 offen offset:0 lds
  buffer_load_dwordx4 v7, s[8:11], s67 offen offset:1024 lds
  s_add_u32 m0, s65, 8192
  s_nop 0
  buffer_load_dwordx4 v8, s[8:11], s67 offen offset:0 lds
  buffer_load_dwordx4 v9, s[8:11], s67 offen offset:1024 lds
  s_add_u32 m0, s65, 16384
  s_nop 0
  buffer_load_dwordx4 v10, s[8:11], s67 offen offset:0 lds
  buffer_load_dwordx4 v11, s[8:11], s67 offen offset:1024 lds
  s_add_u32 s67, s67, 393216
  s_add_u32 s65, s65, 24576
  s_cmp_eq_u32 s64, s70
  s_cselect_b32 s56, 49152, 0
  s_cselect_b32 s57, 73728, 0
  s_sub_u32 s64, s64, s56
  s_sub_u32 s65, s65, s57
  s_cmp_eq_u32 s66, 2048
  s_cselect_b32 s66, 0, s66
  s_cselect_b32 s67, 0, s67
  s_mov_b32 m0, s64
  s_add_u32 s64, s64, 16384
  buffer_load_dwordx4 v2, s[4:7], s66 offen offset:0 lds
  buffer_load_dwordx4 v3, s[4:7], s66 offen offset:1024 lds
  buffer_load_dwordx4 v4, s[4:7], s66 offen offset:2048 lds
  buffer_load_dwordx4 v5, s[4:7], s66 offen offset:3072 lds
  s_add_u32 m0, s65, 0
  s_add_u32 s66, s66, 128
  buffer_load_dwordx4 v6, s[8:11], s67 offen offset:0 lds
  buffer_load_dwordx4 v7, s[8:11], s67 offen offset:1024 lds
  s_add_u32 m0, s65, 8192
  s_nop 0
  buffer_load_dwordx4 v8, s[8:11], s67 offen offset:0 lds
  buffer_load_dwordx4 v9, s[8:11], s67 offen offset:1024 lds
  s_add_u32 m0, s65, 16384
  s_nop 0
  buffer_load_dwordx4 v10, s[8:11], s67 offen offset:0 lds
  buffer_load_dwordx4 v11, s[8:11], s67 offen offset:1024 lds
  s_add_u32 s67, s67, 393216
  s_add_u32 s65, s65, 24576
  s_cmp_eq_u32 s64, s70
  s_cselect_b32 s56, 49152, 0
  s_cselect_b32 s57, 73728, 0
  s_sub_u32 s64, s64, s56
  s_sub_u32 s65, s65, s57
  s_cmp_eq_u32 s66, 2048
  s_cselect_b32 s66, 0, s66
  s_cselect_b32 s67, 0, s67
  s_mov_b32 s18, 4194304
  s_mov_b32 s19, 0x20000
  s_mov_b32 s22, 4194304
  s_mov_b32 s23, 0x20000
  s_mov_b32 s26, 8192
  s_mov_b32 s27, 0x20000
  s_mov_b32 s30, 4194304
  s_mov_b32 s31, 0x20000
  s_mov_b32 s34, 2048
  s_mov_b32 s35, 0x20000
  s_mov_b32 s38, 2097152
  s_mov_b32 s39, 0x20000
  s_mov_b32 s46, 4194304
  s_mov_b32 s47, 0x20000
  s_mov_b32 s42, 8388608
  s_mov_b32 s43, 0x20000
  v_lshrrev_b32 v240, 3, v250
  v_lshlrev_b32 v240, 11, v240
  v_lshrrev_b32 v241, 4, v250
  v_and_b32 v241, 1, v241
  v_lshlrev_b32 v241, 2, v241
  v_and_b32 v242, 7, v250
  v_xor_b32 v241, v241, v242
  v_lshl_add_u32 v240, v241, 4, v240
  s_lshl_b32 s56, s55, 7
  v_add_u32 v244, s56, v240
  v_add_u32 v245, 15360, v244
  v_add_u32 v246, 30720, v244
  v_add_u32 v247, 46080, v244
  v_and_b32 v24, 15, v250
  v_lshlrev_b32 v24, 3, v24
  s_lshl_b32 s56, s49, 7
  v_add_u32 v24, s56, v24
  v_lshrrev_b32 v25, 4, v250
  v_lshlrev_b32 v25, 3, v25
  s_lshl_b32 s56, s48, 7
  s_lshl_b32 s57, s69, 5
  s_add_u32 s56, s56, s57
  v_add_u32 v25, s56, v25
  v_lshl_add_u32 v12, v25, 11, v24
  v_mov_b32 v26, 0x80000000
  v_cmp_eq_u32 vcc, 0, v25
  v_lshlrev_b32 v36, 2, v24
  v_lshlrev_b32 v15, 11, v24
  v_lshlrev_b32 v27, 1, v25
  v_sub_u32 v27, 4080, v27
  v_add_u32 v15, v15, v27
  v_lshlrev_b32 v13, 4, v250
  v_add_u32 v14, 2, v13
  v_mov_b32 v176, 0
  v_mov_b32 v177, 0
  v_mov_b32 v178, 0
  v_mov_b32 v179, 0
  v_subrev_u32 v37, 6144, v12
  v_subrev_u32 v38, 4096, v12
  v_subrev_u32 v39, 2048, v12
  v_cndmask_b32 v37, v37, v26, vcc
  v_cndmask_b32 v38, v38, v26, vcc
  v_cndmask_b32 v39, v39, v26, vcc
  s_mov_b32 s72, 4096
  s_mov_b32 s73, 8192
  s_mov_b32 s74, 12288
  s_lshl_b32 s71, s49, 6
  s_lshl_b32 s56, s48, 2
  s_add_u32 s71, s71, s56
  s_add_u32 s71, s71, s69
  s_setprio 1
  s_waitcnt lgkmcnt(0)
  s_add_u32 s51, s51, 1
  s_not_b32 s56, s51
  v_mov_b32 v26, s56
  v_lshlrev_b32 v27, 2, v250
  v_add_u32 v27, 160512, v27
  s_mov_b32 exec_hi, 0
  ds_write_b32 v27, v26
  s_mov_b64 exec, -1
  s_waitcnt vmcnt(10) lgkmcnt(0)
  s_barrier
L_hloop:
L_hissue:
  s_mov_b32 m0, s64
  s_add_u32 s64, s64, 16384
  buffer_load_dwordx4 v2, s[4:7], s66 offen offset:0 lds
  buffer_load_dwordx4 v3, s[4:7], s66 offen offset:1024 lds
  buffer_load_dwordx4 v4, s[4:7], s66 offen offset:2048 lds
  buffer_load_dwordx4 v5, s[4:7], s66 offen offset:3072 lds
  s_add_u32 m0, s65, 0
  s_add_u32 s66, s66, 128
  buffer_load_dwordx4 v6, s[8:11], s67 offen offset:0 lds
  buffer_load_dwordx4 v7, s[8:11], s67 offen offset:1024 lds
  s_add_u32 m0, s65, 8192
  s_nop 0
  buffer_load_dwordx4 v8, s[8:11], s67 offen offset:0 lds
  buffer_load_dwordx4 v9, s[8:11], s67 offen offset:1024 lds
  s_add_u32 m0, s65, 16384
  s_nop 0
  buffer_load_dwordx4 v10, s[8:11], s67 offen offset:0 lds
  buffer_load_dwordx4 v11, s[8:11], s67 offen offset:1024 lds
  s_add_u32 s67, s67, 393216
  s_add_u32 s65, s65, 24576
  s_cmp_eq_u32 s64, s70
  s_cselect_b32 s56, 49152, 0
  s_cselect_b32 s57, 73728, 0
  s_sub_u32 s64, s64, s56
  s_sub_u32 s65, s65, s57
  s_cmp_eq_u32 s66, 2048
  s_cselect_b32 s66, 0, s66
  s_cselect_b32 s67, 0, s67
  s_cmp_eq_u32 s68, 2
  s_cbranch_scc1 L_hside2
  s_cmp_eq_u32 s68, 3
  s_cbranch_scc1 L_hside3
  s_cmp_eq_u32 s68, 4
  s_cbranch_scc1 L_hside4
  s_cmp_eq_u32 s68, 5
  s_cbranch_scc1 L_hside5
  s_cmp_eq_u32 s68, 7
  s_cbranch_scc1 L_hside7
  s_cmp_eq_u32 s68, 8
  s_cbranch_scc1 L_hside8
  s_cmp_eq_u32 s68, 9
  s_cbranch_scc1 L_hside9
  s_cmp_eq_u32 s68, 10
  s_cbranch_scc1 L_hside10
  s_cmp_eq_u32 s68, 11
  s_cbranch_scc1 L_hside11
  s_cmp_eq_u32 s68, 12
  s_cbranch_scc1 L_hside12
  s_cmp_eq_u32 s68, 13
  s_cbranch_scc1 L_hside13
  s_waitcnt vmcnt(10)
L_htail:
  s_add_u32 s68, s68, 1
  s_cmp_lg_u32 s68, 14
  s_barrier
  s_cbranch_scc1 L_hloop
  s_waitcnt vmcnt(1)
  s_lshl_b32 s56, s49, 8
  s_lshl_b32 s57, s48, 4
  s_add_u32 s56, s56, s57
  s_lshl_b32 s57, s69, 2
  s_add_u32 s56, s56, s57
  s_add_u32 s56, s56, 4096
  v_mov_b32 v16, 0
  v_mov_b32 v17, s51
  s_mov_b64 exec, 1
  buffer_store_dword v17, v16, s[12:15], s56 offen sc1
  s_mov_b64 exec, -1
  s_barrier
  s_barrier
  s_lshl_b32 s56, s71, 12
  s_mul_i32 s57, s69, 8320
  s_add_u32 m0, s57, 122912
  s_nop 0
  buffer_load_dwordx4 v13, s[28:31], s56 offen offset:0 nt lds
  buffer_load_dwordx4 v13, s[28:31], s56 offen offset:1024 nt lds
  buffer_load_dwordx4 v13, s[28:31], s56 offen offset:2048 nt lds
  buffer_load_dwordx4 v13, s[28:31], s56 offen offset:3072 nt lds
  s_add_u32 m0, s57, 127072
  s_nop 0
  buffer_load_dwordx4 v14, s[28:31], s56 offen offset:0 nt lds
  buffer_load_dwordx4 v14, s[28:31], s56 offen offset:1024 nt lds
  buffer_load_dwordx4 v14, s[28:31], s56 offen offset:2048 nt lds
  buffer_load_dwordx4 v14, s[28:31], s56 offen offset:3072 nt lds
  s_lshl_b32 s56, s71, 1
  v_mov_b32 v35, 0
  buffer_load_ushort v35, v35, s[32:35], s56 offen
  v_lshlrev_b32 v16, 2, v250
  s_lshl_b32 s57, s49, 8
  s_add_u32 s57, s57, 4096
  s_mov_b32 s63, 20000
pf1_1:
  buffer_load_dword v17, v16, s[12:15], s57 offen sc1
  s_waitcnt vmcnt(0)
  v_cmp_ne_u32 vcc, s51, v17
  s_cbranch_vccz pf1d_2
  s_sub_u32 s63, s63, 1
  s_cbranch_scc1 pf1d_2
  s_sleep 1
  s_branch pf1_1
pf1d_2:
  s_lshl_b32 s56, s71, 12
  s_add_u32 s56, s56, 65536
  buffer_load_dwordx4 v[40:43], v13, s[12:15], s56 offen offset:0 sc1
  buffer_load_dwordx4 v[44:47], v13, s[12:15], s56 offen offset:1024 sc1
  buffer_load_dwordx4 v[48:51], v13, s[12:15], s56 offen offset:2048 sc1
  buffer_load_dwordx4 v[52:55], v13, s[12:15], s56 offen offset:3072 sc1
  s_mul_i32 s57, s69, 8320
  s_add_u32 s57, s57, 122880
  v_mov_b32 v16, s57
  ds_read_u16 v17, v16 offset:32
  v_lshlrev_b32 v35, 16, v35
  s_waitcnt lgkmcnt(0)
  v_lshlrev_b32 v17, 16, v17
  v_add_f32 v17, v17, v35
  v_cvt_pk_bf16_f32 v17, v17, v17
  v_and_b32 v18, 0xffff0000, v17
  s_mov_b64 exec, 1
  ds_write_b128 v16, v[176:179]
  ds_write_b128 v16, v[176:179] offset:16
  ds_write_b16 v16, v17 offset:32
  ds_write_b128 v16, v[176:179] offset:4160
  ds_write_b64 v16, v[176:177] offset:4176
  ds_write_b32 v16, v176 offset:4184
  ds_write_b32 v16, v18 offset:4188
  s_mov_b64 exec, -1
  s_waitcnt lgkmcnt(0)
  s_mul_i32 s57, s69, 4576
  s_add_u32 s57, s57, 73728
  v_add_u32 v16, s57, v13
  v_cmp_gt_u32 vcc, 30, v250
  s_and_saveexec_b64 s[60:61], vcc
  ds_write_b128 v16, v[176:179] offset:4096
  s_mov_b64 exec, s[60:61]
  s_waitcnt vmcnt(0)
  ds_write_b128 v16, v[40:43] offset:0
  ds_write_b128 v16, v[44:47] offset:1024
  ds_write_b128 v16, v[48:51] offset:2048
  ds_write_b128 v16, v[52:55] offset:3072
  s_waitcnt lgkmcnt(0)
  s_barrier
  s_branch L_helper
L_hside2:
  buffer_load_dwordx4 v[80:83], v36, s[24:27], 0 offen offset:0
  buffer_load_dwordx4 v[84:87], v36, s[24:27], 0 offen offset:16
  buffer_load_dwordx2 v[40:41], v37, s[16:19], 0 offen nt
  buffer_load_dwordx2 v[42:43], v38, s[16:19], 0 offen nt
  buffer_load_dwordx2 v[44:45], v39, s[16:19], 0 offen nt
  buffer_load_dwordx2 v[46:47], v12, s[16:19], 0 offen offset:0 nt
  buffer_load_dwordx2 v[48:49], v12, s[16:19], 0 offen offset:2048 nt
  s_waitcnt vmcnt(17)
  s_branch L_htail
L_hside3:
  buffer_load_dwordx2 v[50:51], v12, s[16:19], s72 offen offset:0 nt
  buffer_load_dwordx2 v[52:53], v12, s[16:19], s72 offen offset:2048 nt
  buffer_load_dwordx2 v[54:55], v12, s[16:19], s73 offen offset:0 nt
  buffer_load_dwordx2 v[56:57], v12, s[16:19], s73 offen offset:2048 nt
  buffer_load_dwordx2 v[58:59], v12, s[16:19], s74 offen offset:0 nt
  buffer_load_dwordx2 v[60:61], v12, s[16:19], s74 offen offset:2048 nt
  buffer_load_dwordx2 v[64:65], v12, s[20:23], 0 offen offset:0 nt
  s_waitcnt vmcnt(24)
  s_branch L_htail
L_hside4:
  buffer_load_dwordx2 v[66:67], v12, s[20:23], 0 offen offset:2048 nt
  buffer_load_dwordx2 v[68:69], v12, s[20:23], s72 offen offset:0 nt
  buffer_load_dwordx2 v[70:71], v12, s[20:23], s72 offen offset:2048 nt
  buffer_load_dwordx2 v[72:73], v12, s[20:23], s73 offen offset:0 nt
  buffer_load_dwordx2 v[74:75], v12, s[20:23], s73 offen offset:2048 nt
  buffer_load_dwordx2 v[76:77], v12, s[20:23], s74 offen offset:0 nt
  buffer_load_dwordx2 v[78:79], v12, s[20:23], s74 offen offset:2048 nt
  s_waitcnt vmcnt(24)
  s_branch L_htail
L_hside5:
  s_waitcnt vmcnt(17)
  s_branch L_htail
L_hside7:
L_hval7:
  v_lshlrev_b32 v134, 16, v80
  v_and_b32 v136, 0xffff0000, v80
  v_lshlrev_b32 v138, 16, v81
  v_and_b32 v140, 0xffff0000, v81
  v_lshlrev_b32 v135, 16, v82
  v_and_b32 v137, 0xffff0000, v82
  v_lshlrev_b32 v139, 16, v83
  v_and_b32 v141, 0xffff0000, v83
  v_lshlrev_b32 v112, 16, v40
  v_and_b32 v113, 0xffff0000, v40
  v_lshlrev_b32 v114, 16, v42
  v_and_b32 v115, 0xffff0000, v42
  v_lshlrev_b32 v116, 16, v44
  v_and_b32 v117, 0xffff0000, v44
  v_lshlrev_b32 v118, 16, v46
  v_and_b32 v119, 0xffff0000, v46
  v_lshlrev_b32 v120, 16, v48
  v_and_b32 v121, 0xffff0000, v48
  v_lshlrev_b32 v122, 16, v50
  v_and_b32 v123, 0xffff0000, v50
  v_lshlrev_b32 v124, 16, v52
  v_and_b32 v125, 0xffff0000, v52
  v_lshlrev_b32 v126, 16, v54
  v_and_b32 v127, 0xffff0000, v54
  v_lshlrev_b32 v128, 16, v56
  v_and_b32 v129, 0xffff0000, v56
  v_lshlrev_b32 v130, 16, v58
  v_and_b32 v131, 0xffff0000, v58
  v_lshlrev_b32 v132, 16, v60
  v_and_b32 v133, 0xffff0000, v60
  v_pk_mul_f32 v[142:143], v[118:119], v[134:135]
  v_pk_fma_f32 v[142:143], v[116:117], v[136:137], v[142:143]
  v_pk_fma_f32 v[142:143], v[114:115], v[138:139], v[142:143]
  v_pk_fma_f32 v[142:143], v[112:113], v[140:141], v[142:143]
  v_lshlrev_b32 v158, 16, v64
  v_and_b32 v159, 0xffff0000, v64
  v_pk_mul_f32 v[142:143], v[142:143], v[158:159]
  v_pk_mul_f32 v[144:145], v[120:121], v[134:135]
  v_pk_fma_f32 v[144:145], v[118:119], v[136:137], v[144:145]
  v_pk_fma_f32 v[144:145], v[116:117], v[138:139], v[144:145]
  v_pk_fma_f32 v[144:145], v[114:115], v[140:141], v[144:145]
  v_lshlrev_b32 v158, 16, v66
  v_and_b32 v159, 0xffff0000, v66
  v_pk_mul_f32 v[144:145], v[144:145], v[158:159]
L_hwait7:
  s_waitcnt vmcnt(10)
  s_branch L_htail
L_hside8:
L_hval8:
  v_pk_mul_f32 v[146:147], v[122:123], v[134:135]
  v_pk_fma_f32 v[146:147], v[120:121], v[136:137], v[146:147]
  v_pk_fma_f32 v[146:147], v[118:119], v[138:139], v[146:147]
  v_pk_fma_f32 v[146:147], v[116:117], v[140:141], v[146:147]
  v_lshlrev_b32 v158, 16, v68
  v_and_b32 v159, 0xffff0000, v68
  v_pk_mul_f32 v[146:147], v[146:147], v[158:159]
  v_pk_mul_f32 v[148:149], v[124:125], v[134:135]
  v_pk_fma_f32 v[148:149], v[122:123], v[136:137], v[148:149]
  v_pk_fma_f32 v[148:149], v[120:121], v[138:139], v[148:149]
  v_pk_fma_f32 v[148:149], v[118:119], v[140:141], v[148:149]
  v_lshlrev_b32 v158, 16, v70
  v_and_b32 v159, 0xffff0000, v70
  v_pk_mul_f32 v[148:149], v[148:149], v[158:159]
  v_pk_mul_f32 v[150:151], v[126:127], v[134:135]
  v_pk_fma_f32 v[150:151], v[124:125], v[136:137], v[150:151]
  v_pk_fma_f32 v[150:151], v[122:123], v[138:139], v[150:151]
  v_pk_fma_f32 v[150:151], v[120:121], v[140:141], v[150:151]
  v_lshlrev_b32 v158, 16, v72
  v_and_b32 v159, 0xffff0000, v72
  v_pk_mul_f32 v[150:151], v[150:151], v[158:159]
  v_pk_mul_f32 v[152:153], v[128:129], v[134:135]
  v_pk_fma_f32 v[152:153], v[126:127], v[136:137], v[152:153]
  v_pk_fma_f32 v[152:153], v[124:125], v[138:139], v[152:153]
  v_pk_fma_f32 v[152:153], v[122:123], v[140:141], v[152:153]
  v_lshlrev_b32 v158, 16, v74
  v_and_b32 v159, 0xffff0000, v74
  v_pk_mul_f32 v[152:153], v[152:153], v[158:159]
  v_pk_mul_f32 v[154:155], v[130:131], v[134:135]
  v_pk_fma_f32 v[154:155], v[128:129], v[136:137], v[154:155]
  v_pk_fma_f32 v[154:155], v[126:127], v[138:139], v[154:155]
  v_pk_fma_f32 v[154:155], v[124:125], v[140:141], v[154:155]
  v_lshlrev_b32 v158, 16, v76
  v_and_b32 v159, 0xffff0000, v76
  v_pk_mul_f32 v[154:155], v[154:155], v[158:159]
  v_pk_mul_f32 v[156:157], v[132:133], v[134:135]
  v_pk_fma_f32 v[156:157], v[130:131], v[136:137], v[156:157]
  v_pk_fma_f32 v[156:157], v[128:129], v[138:139], v[156:157]
  v_pk_fma_f32 v[156:157], v[126:127], v[140:141], v[156:157]
  v_lshlrev_b32 v158, 16, v78
  v_and_b32 v159, 0xffff0000, v78
  v_pk_mul_f32 v[156:157], v[156:157], v[158:159]
  v_cvt_pk_bf16_f32 v160, v156, v154
  v_cvt_pk_bf16_f32 v161, v152, v150
  v_cvt_pk_bf16_f32 v162, v148, v146
  v_cvt_pk_bf16_f32 v163, v144, v142
  v_cvt_pk_bf16_f32 v164, v157, v155
  v_cvt_pk_bf16_f32 v165, v153, v151
  v_cvt_pk_bf16_f32 v166, v149, v147
  v_cvt_pk_bf16_f32 v167, v145, v143
L_hwait8:
  s_waitcnt vmcnt(10)
  s_branch L_htail
L_hside9:
L_hval9:
  v_lshlrev_b32 v134, 16, v84
  v_and_b32 v136, 0xffff0000, v84
  v_lshlrev_b32 v138, 16, v85
  v_and_b32 v140, 0xffff0000, v85
  v_lshlrev_b32 v135, 16, v86
  v_and_b32 v137, 0xffff0000, v86
  v_lshlrev_b32 v139, 16, v87
  v_and_b32 v141, 0xffff0000, v87
  v_lshlrev_b32 v112, 16, v41
  v_and_b32 v113, 0xffff0000, v41
  v_lshlrev_b32 v114, 16, v43
  v_and_b32 v115, 0xffff0000, v43
  v_lshlrev_b32 v116, 16, v45
  v_and_b32 v117, 0xffff0000, v45
  v_lshlrev_b32 v118, 16, v47
  v_and_b32 v119, 0xffff0000, v47
  v_lshlrev_b32 v120, 16, v49
  v_and_b32 v121, 0xffff0000, v49
  v_lshlrev_b32 v122, 16, v51
  v_and_b32 v123, 0xffff0000, v51
  v_lshlrev_b32 v124, 16, v53
  v_and_b32 v125, 0xffff0000, v53
  v_lshlrev_b32 v126, 16, v55
  v_and_b32 v127, 0xffff0000, v55
  v_lshlrev_b32 v128, 16, v57
  v_and_b32 v129, 0xffff0000, v57
  v_lshlrev_b32 v130, 16, v59
  v_and_b32 v131, 0xffff0000, v59
  v_lshlrev_b32 v132, 16, v61
  v_and_b32 v133, 0xffff0000, v61
  v_pk_mul_f32 v[142:143], v[118:119], v[134:135]
  v_pk_fma_f32 v[142:143], v[116:117], v[136:137], v[142:143]
  v_pk_fma_f32 v[142:143], v[114:115], v[138:139], v[142:143]
  v_pk_fma_f32 v[142:143], v[112:113], v[140:141], v[142:143]
  v_lshlrev_b32 v158, 16, v65
  v_and_b32 v159, 0xffff0000, v65
  v_pk_mul_f32 v[142:143], v[142:143], v[158:159]
  v_pk_mul_f32 v[144:145], v[120:121], v[134:135]
  v_pk_fma_f32 v[144:145], v[118:119], v[136:137], v[144:145]
  v_pk_fma_f32 v[144:145], v[116:117], v[138:139], v[144:145]
  v_pk_fma_f32 v[144:145], v[114:115], v[140:141], v[144:145]
  v_lshlrev_b32 v158, 16, v67
  v_and_b32 v159, 0xffff0000, v67
  v_pk_mul_f32 v[144:145], v[144:145], v[158:159]
L_hwait9:
  s_waitcnt vmcnt(10)
  s_branch L_htail
L_hside10:
L_hval10:
  v_pk_mul_f32 v[146:147], v[122:123], v[134:135]
  v_pk_fma_f32 v[146:147], v[120:121], v[136:137], v[146:147]
  v_pk_fma_f32 v[146:147], v[118:119], v[138:139], v[146:147]
  v_pk_fma_f32 v[146:147], v[116:117], v[140:141], v[146:147]
  v_lshlrev_b32 v158, 16, v69
  v_and_b32 v159, 0xffff0000, v69
  v_pk_mul_f32 v[146:147], v[146:147], v[158:159]
  v_pk_mul_f32 v[148:149], v[124:125], v[134:135]
  v_pk_fma_f32 v[148:149], v[122:123], v[136:137], v[148:149]
  v_pk_fma_f32 v[148:149], v[120:121], v[138:139], v[148:149]
  v_pk_fma_f32 v[148:149], v[118:119], v[140:141], v[148:149]
  v_lshlrev_b32 v158, 16, v71
  v_and_b32 v159, 0xffff0000, v71
  v_pk_mul_f32 v[148:149], v[148:149], v[158:159]
  v_pk_mul_f32 v[150:151], v[126:127], v[134:135]
  v_pk_fma_f32 v[150:151], v[124:125], v[136:137], v[150:151]
  v_pk_fma_f32 v[150:151], v[122:123], v[138:139], v[150:151]
  v_pk_fma_f32 v[150:151], v[120:121], v[140:141], v[150:151]
  v_lshlrev_b32 v158, 16, v73
  v_and_b32 v159, 0xffff0000, v73
  v_pk_mul_f32 v[150:151], v[150:151], v[158:159]
  v_pk_mul_f32 v[152:153], v[128:129], v[134:135]
  v_pk_fma_f32 v[152:153], v[126:127], v[136:137], v[152:153]
  v_pk_fma_f32 v[152:153], v[124:125], v[138:139], v[152:153]
  v_pk_fma_f32 v[152:153], v[122:123], v[140:141], v[152:153]
  v_lshlrev_b32 v158, 16, v75
  v_and_b32 v159, 0xffff0000, v75
  v_pk_mul_f32 v[152:153], v[152:153], v[158:159]
  v_pk_mul_f32 v[154:155], v[130:131], v[134:135]
  v_pk_fma_f32 v[154:155], v[128:129], v[136:137], v[154:155]
  v_pk_fma_f32 v[154:155], v[126:127], v[138:139], v[154:155]
  v_pk_fma_f32 v[154:155], v[124:125], v[140:141], v[154:155]
  v_lshlrev_b32 v158, 16, v77
  v_and_b32 v159, 0xffff0000, v77
  v_pk_mul_f32 v[154:155], v[154:155], v[158:159]
  v_pk_mul_f32 v[156:157], v[132:133], v[134:135]
  v_pk_fma_f32 v[156:157], v[130:131], v[136:137], v[156:157]
  v_pk_fma_f32 v[156:157], v[128:129], v[138:139], v[156:157]
  v_pk_fma_f32 v[156:157], v[126:127], v[140:141], v[156:157]
  v_lshlrev_b32 v158, 16, v79
  v_and_b32 v159, 0xffff0000, v79
  v_pk_mul_f32 v[156:157], v[156:157], v[158:159]
  v_cvt_pk_bf16_f32 v168, v156, v154
  v_cvt_pk_bf16_f32 v169, v152, v150
  v_cvt_pk_bf16_f32 v170, v148, v146
  v_cvt_pk_bf16_f32 v171, v144, v142
  v_cvt_pk_bf16_f32 v172, v157, v155
  v_cvt_pk_bf16_f32 v173, v153, v151
  v_cvt_pk_bf16_f32 v174, v149, v147
  v_cvt_pk_bf16_f32 v175, v145, v143
L_hwait10:
  s_waitcnt vmcnt(10)
  s_branch L_htail
L_hside11:
  s_mov_b32 s56, 65536
  buffer_store_dwordx4 v[160:163], v15, s[12:15], s56 offen sc1
  s_mov_b32 s56, 69632
  buffer_store_dwordx4 v[164:167], v15, s[12:15], s56 offen sc1
  s_mov_b32 s56, 73728
  buffer_store_dwordx4 v[168:171], v15, s[12:15], s56 offen sc1
  s_mov_b32 s56, 77824
  buffer_store_dwordx4 v[172:175], v15, s[12:15], s56 offen sc1
  s_waitcnt vmcnt(14)
  s_branch L_htail
L_hside12:
  s_lshl_b32 s56, s2, 2
  s_add_u32 s56, s56, s69
  s_lshl_b32 s56, s56, 11
  v_lshlrev_b32 v16, 7, v250
  s_mov_b64 exec, 0xffff
  buffer_load_dword v251, v16, s[36:39], s56 offen
  s_mov_b64 exec, -1
  s_waitcnt vmcnt(15)
  s_branch L_htail
L_hside13:
  s_lshr_b32 s56, s2, 3
  s_lshl_b32 s56, s56, 2
  s_add_u32 s56, s56, s69
  s_lshl_b32 s56, s56, 14
  s_add_u32 s56, s56, 384
  v_and_b32 v16, 7, v250
  v_lshlrev_b32 v16, 11, v16
  v_lshrrev_b32 v17, 3, v250
  v_lshl_add_u32 v16, v17, 10, v16
  s_mov_b64 exec, 0xffff
  buffer_load_dword v251, v16, s[36:39], s56 offen
  s_mov_b64 exec, -1
  s_waitcnt vmcnt(12)
  s_branch L_htail
L_compute:
  s_waitcnt lgkmcnt(0)
  s_load_dword s51, s[12:13], 0
L_pfdone:
  s_mov_b32 s18, 4194304
  s_mov_b32 s19, 0x20000
  s_mov_b32 s22, 4194304
  s_mov_b32 s23, 0x20000
  s_and_b32 s56, s2, 7
  s_lshr_b32 s57, s2, 3
  s_lshl_b32 s57, s57, 5
  v_and_b32 v150, 31, v250
  v_add_u32 v150, s57, v150
  v_lshrrev_b32 v151, 5, v250
  s_lshr_b32 s58, s56, 1
  s_lshl_b32 s58, s58, 2
  s_add_u32 s58, s58, 3
  s_lshl_b32 s58, s58, 7
  s_and_b32 s59, s56, 1
  s_lshl_b32 s59, s59, 21
  s_mov_b32 s71, 0
  s_mov_b32 s70, 0
  v_mov_b32 v146, 0
  s_cmp_eq_u32 s50, 2
  s_cbranch_scc1 L_c3x
  s_bitcmp1_b32 s2, 1
  s_cbranch_scc1 L_c3done
  s_cmp_eq_u32 s50, 3
  s_cbranch_scc1 L_c3k
  s_movk_i32 s60, 6144
  v_mul_lo_u32 v146, v150, s60
  v_lshl_add_u32 v146, v151, 11, v146
  s_lshl_b32 s60, s50, 12
  s_add_u32 s70, s58, s60
  s_add_u32 s71, s50, 1
  s_branch L_c3done
L_c3x:
  s_branch L_c3done
L_c3k:
L_c3done:
  s_mov_b32 s38, 2097152
  s_mov_b32 s39, 0x20000
  s_mov_b32 s46, 4194304
  s_mov_b32 s47, 0x20000
  s_mov_b32 s42, 8388608
  s_mov_b32 s43, 0x20000
  s_lshr_b32 s52, s50, 1
  s_and_b32 s53, s50, 1
  v_and_b32 v150, 31, v250
  s_lshl_b32 s56, s52, 6
  v_add_u32 v150, s56, v150
  v_lshlrev_b32 v150, 7, v150
  v_lshrrev_b32 v151, 1, v250
  v_and_b32 v151, 7, v151
  v_lshrrev_b32 v152, 5, v250
  v_xor_b32 v151, v151, v152
  v_xor_b32 v153, 0, v151
  v_lshl_add_u32 v136, v153, 4, v150
  v_xor_b32 v153, 2, v151
  v_lshl_add_u32 v137, v153, 4, v150
  v_xor_b32 v153, 4, v151
  v_lshl_add_u32 v138, v153, 4, v150
  v_xor_b32 v153, 6, v151
  v_lshl_add_u32 v139, v153, 4, v150
  v_lshrrev_b32 v150, 5, v250
  v_lshlrev_b32 v150, 3, v150
  v_and_b32 v151, 15, v250
  v_lshrrev_b32 v151, 2, v151
  v_add_u32 v150, v150, v151
  v_lshlrev_b32 v150, 7, v150
  v_lshrrev_b32 v151, 4, v250
  v_and_b32 v151, 1, v151
  v_lshlrev_b32 v151, 1, v151
  v_and_b32 v152, 3, v250
  v_lshrrev_b32 v152, 1, v152
  v_add_u32 v151, v151, v152
  s_lshl_b32 s56, s53, 2
  v_add_u32 v151, s56, v151
  v_lshrrev_b32 v152, 3, v250
  v_and_b32 v152, 1, v152
  v_lshlrev_b32 v152, 2, v152
  v_xor_b32 v151, v151, v152
  v_lshl_add_u32 v150, v151, 4, v150
  v_and_b32 v151, 1, v250
  v_lshl_add_u32 v150, v151, 3, v150
  v_add_u32 v140, 49152, v150
  v_mov_b32 v0, 0
  v_mov_b32 v1, 0
  v_mov_b32 v2, 0
  v_mov_b32 v3, 0
  v_mov_b32 v4, 0
  v_mov_b32 v5, 0
  v_mov_b32 v6, 0
  v_mov_b32 v7, 0
  v_mov_b32 v8, 0
  v_mov_b32 v9, 0
  v_mov_b32 v10, 0
  v_mov_b32 v11, 0
  v_mov_b32 v12, 0
  v_mov_b32 v13, 0
  v_mov_b32 v14, 0
  v_mov_b32 v15, 0
  v_mov_b32 v16, 0
  v_mov_b32 v17, 0
  v_mov_b32 v18, 0
  v_mov_b32 v19, 0
  v_mov_b32 v20, 0
  v_mov_b32 v21, 0
  v_mov_b32 v22, 0
  v_mov_b32 v23, 0
  v_mov_b32 v24, 0
  v_mov_b32 v25, 0
  v_mov_b32 v26, 0
  v_mov_b32 v27, 0
  v_mov_b32 v28, 0
  v_mov_b32 v29, 0
  v_mov_b32 v30, 0
  v_mov_b32 v31, 0
  v_mov_b32 v32, 0
  v_mov_b32 v33, 0
  v_mov_b32 v34, 0
  v_mov_b32 v35, 0
  v_mov_b32 v36, 0
  v_mov_b32 v37, 0
  v_mov_b32 v38, 0
  v_mov_b32 v39, 0
  v_mov_b32 v40, 0
  v_mov_b32 v41, 0
  v_mov_b32 v42, 0
  v_mov_b32 v43, 0
  v_mov_b32 v44, 0
  v_mov_b32 v45, 0
  v_mov_b32 v46, 0
  v_mov_b32 v47, 0
  v_mov_b32 v48, 0
  v_mov_b32 v49, 0
  v_mov_b32 v50, 0
  v_mov_b32 v51, 0
  v_mov_b32 v52, 0
  v_mov_b32 v53, 0
  v_mov_b32 v54, 0
  v_mov_b32 v55, 0
  v_mov_b32 v56, 0
  v_mov_b32 v57, 0
  v_mov_b32 v58, 0
  v_mov_b32 v59, 0
  v_mov_b32 v60, 0
  v_mov_b32 v61, 0
  v_mov_b32 v62, 0
  v_mov_b32 v63, 0
  v_mov_b32 v64, 0
  v_mov_b32 v65, 0
  v_mov_b32 v66, 0
  v_mov_b32 v67, 0
  v_mov_b32 v68, 0
  v_mov_b32 v69, 0
  v_mov_b32 v70, 0
  v_mov_b32 v71, 0
  v_mov_b32 v72, 0
  v_mov_b32 v73, 0
  v_mov_b32 v74, 0
  v_mov_b32 v75, 0
  v_mov_b32 v76, 0
  v_mov_b32 v77, 0
  v_mov_b32 v78, 0
  v_mov_b32 v79, 0
  v_mov_b32 v80, 0
  v_mov_b32 v81, 0
  v_mov_b32 v82, 0
  v_mov_b32 v83, 0
  v_mov_b32 v84, 0
  v_mov_b32 v85, 0
  v_mov_b32 v86, 0
  v_mov_b32 v87, 0
  v_mov_b32 v88, 0
  v_mov_b32 v89, 0
  v_mov_b32 v90, 0
  v_mov_b32 v91, 0
  v_mov_b32 v92, 0
  v_mov_b32 v93, 0
  v_mov_b32 v94, 0
  v_mov_b32 v95, 0
  s_mov_b32 s64, 16384
  s_mov_b32 s65, -32768
  s_mov_b32 s66, 24576
  s_mov_b32 s67, -49152
  s_mov_b32 s68, 0
  s_mov_b32 s69, 0
  s_waitcnt lgkmcnt(0)
  s_add_u32 s51, s51, 1
  s_setprio 3
  s_barrier
  s_cmp_eq_u32 s71, 0
  s_cbranch_scc1 c3_3e
  s_cmp_eq_u32 s71, 3
  s_cbranch_scc1 c3_3x
  s_cmp_eq_u32 s71, 4
  s_cbranch_scc1 c3_3k
  s_cmp_eq_u32 s71, 1
  s_cbranch_scc1 c3_3w
  s_mov_b32 exec_hi, 0
  c3_3w:
  buffer_load_dword v251, v146, s[8:11], s70 offen
  s_mov_b64 exec, -1
  s_branch c3_3e
  c3_3x:
  buffer_load_dword v251, v146, s[4:7], s70 offen
  s_branch c3_3e
  c3_3k:
  s_mov_b32 exec_hi, 0
  buffer_load_dword v251, v146, s[16:19], s70 offen
  s_not_b64 exec, exec
  buffer_load_dword v251, v146, s[20:23], s70 offen
  s_mov_b64 exec, -1
  c3_3e:
  s_mov_b32 s71, 0
  ds_read_b128 v[96:99], v136 offset:0
  ds_read_b64_tr_b16 v[104:105], v140 offset:0
  ds_read_b64_tr_b16 v[106:107], v140 offset:512
  ds_read_b128 v[100:103], v136 offset:4096
  ds_read_b64_tr_b16 v[108:109], v140 offset:8192
  ds_read_b64_tr_b16 v[110:111], v140 offset:8704
  ds_read_b64_tr_b16 v[112:113], v140 offset:16384
  ds_read_b64_tr_b16 v[114:115], v140 offset:16896
L_g1loop:
  s_waitcnt lgkmcnt(5)
  v_mfma_f32_32x32x16_bf16 v[0:15], v[104:107], v[96:99], v[0:15]
  ds_read_b128 v[116:119], v137 offset:0
  ds_read_b64_tr_b16 v[124:125], v140 offset:2048
  s_waitcnt lgkmcnt(6)
  v_mfma_f32_32x32x16_bf16 v[16:31], v[104:107], v[100:103], v[16:31]
  ds_read_b64_tr_b16 v[126:127], v140 offset:2560
  ds_read_b128 v[120:123], v137 offset:4096
  s_waitcnt lgkmcnt(6)
  v_mfma_f32_32x32x16_bf16 v[32:47], v[96:99], v[108:111], v[32:47]
  ds_read_b64_tr_b16 v[128:129], v140 offset:10240
  ds_read_b64_tr_b16 v[130:131], v140 offset:10752
  v_mfma_f32_32x32x16_bf16 v[48:63], v[100:103], v[108:111], v[48:63]
  ds_read_b64_tr_b16 v[132:133], v140 offset:18432
  ds_read_b64_tr_b16 v[134:135], v140 offset:18944
  s_waitcnt lgkmcnt(8)
  v_mfma_f32_32x32x16_bf16 v[64:79], v[96:99], v[112:115], v[64:79]
  v_mfma_f32_32x32x16_bf16 v[80:95], v[100:103], v[112:115], v[80:95]
  s_waitcnt lgkmcnt(5)
  v_mfma_f32_32x32x16_bf16 v[0:15], v[124:127], v[116:119], v[0:15]
  ds_read_b128 v[96:99], v138 offset:0
  ds_read_b64_tr_b16 v[104:105], v140 offset:4096
  s_waitcnt lgkmcnt(6)
  v_mfma_f32_32x32x16_bf16 v[16:31], v[124:127], v[120:123], v[16:31]
  ds_read_b64_tr_b16 v[106:107], v140 offset:4608
  ds_read_b128 v[100:103], v138 offset:4096
  s_waitcnt lgkmcnt(6)
  v_mfma_f32_32x32x16_bf16 v[32:47], v[116:119], v[128:131], v[32:47]
  ds_read_b64_tr_b16 v[108:109], v140 offset:12288
  ds_read_b64_tr_b16 v[110:111], v140 offset:12800
  v_mfma_f32_32x32x16_bf16 v[48:63], v[120:123], v[128:131], v[48:63]
  ds_read_b64_tr_b16 v[112:113], v140 offset:20480
  ds_read_b64_tr_b16 v[114:115], v140 offset:20992
  s_waitcnt lgkmcnt(8)
  v_mfma_f32_32x32x16_bf16 v[64:79], v[116:119], v[132:135], v[64:79]
  v_mfma_f32_32x32x16_bf16 v[80:95], v[120:123], v[132:135], v[80:95]
  s_waitcnt lgkmcnt(5)
  v_mfma_f32_32x32x16_bf16 v[0:15], v[104:107], v[96:99], v[0:15]
  ds_read_b128 v[116:119], v139 offset:0
  ds_read_b64_tr_b16 v[124:125], v140 offset:6144
  s_waitcnt lgkmcnt(6)
  v_mfma_f32_32x32x16_bf16 v[16:31], v[104:107], v[100:103], v[16:31]
  ds_read_b64_tr_b16 v[126:127], v140 offset:6656
  ds_read_b128 v[120:123], v139 offset:4096
  s_waitcnt lgkmcnt(6)
  v_mfma_f32_32x32x16_bf16 v[32:47], v[96:99], v[108:111], v[32:47]
  ds_read_b64_tr_b16 v[128:129], v140 offset:14336
  ds_read_b64_tr_b16 v[130:131], v140 offset:14848
  v_mfma_f32_32x32x16_bf16 v[48:63], v[100:103], v[108:111], v[48:63]
  ds_read_b64_tr_b16 v[132:133], v140 offset:22528
  ds_read_b64_tr_b16 v[134:135], v140 offset:23040
  s_waitcnt lgkmcnt(8)
  v_mfma_f32_32x32x16_bf16 v[64:79], v[96:99], v[112:115], v[64:79]
  v_mfma_f32_32x32x16_bf16 v[80:95], v[100:103], v[112:115], v[80:95]
  s_waitcnt lgkmcnt(5)
  v_mfma_f32_32x32x16_bf16 v[0:15], v[124:127], v[116:119], v[0:15]
  s_waitcnt lgkmcnt(4)
  v_mfma_f32_32x32x16_bf16 v[16:31], v[124:127], v[120:123], v[16:31]
  s_add_u32 s56, s68, 1
  s_cmp_eq_u32 s68, 2
  s_cselect_b32 s68, 0, s56
  s_cselect_b32 s56, s65, s64
  s_cselect_b32 s57, s67, s66
  v_add_u32 v136, s56, v136
  v_add_u32 v137, s56, v137
  v_add_u32 v138, s56, v138
  v_add_u32 v139, s56, v139
  v_add_u32 v140, s57, v140
  s_waitcnt lgkmcnt(0)
  s_barrier
  v_mfma_f32_32x32x16_bf16 v[32:47], v[116:119], v[128:131], v[32:47]
  ds_read_b128 v[96:99], v136 offset:0
  ds_read_b64_tr_b16 v[104:105], v140 offset:0
  v_mfma_f32_32x32x16_bf16 v[48:63], v[120:123], v[128:131], v[48:63]
  ds_read_b64_tr_b16 v[106:107], v140 offset:512
  ds_read_b128 v[100:103], v136 offset:4096
  v_mfma_f32_32x32x16_bf16 v[64:79], v[116:119], v[132:135], v[64:79]
  ds_read_b64_tr_b16 v[108:109], v140 offset:8192
  ds_read_b64_tr_b16 v[110:111], v140 offset:8704
  v_mfma_f32_32x32x16_bf16 v[80:95], v[120:123], v[132:135], v[80:95]
  ds_read_b64_tr_b16 v[112:113], v140 offset:16384
  ds_read_b64_tr_b16 v[114:115], v140 offset:16896
  s_add_u32 s69, s69, 1
  s_cmp_lg_u32 s69, 16
  s_cbranch_scc1 L_g1loop
  s_waitcnt lgkmcnt(0)
  s_mov_b32 s64, 1069066811
  s_mov_b32 s65, 1069066811
  s_mov_b32 s66, 897988541
  s_mov_b32 s67, 897988541
  v_mov_b32 v128, 0x3f803f80
  v_mov_b32 v129, 0x3f803f80
  v_mov_b32 v130, 0x3f803f80
  v_mov_b32 v131, 0x3f803f80
  v_lshlrev_b32 v152, 4, v250
  s_mul_i32 s56, s53, 4224
  s_add_u32 s56, s56, 108544
  v_add_u32 v153, s56, v152
  v_lshrrev_b32 v154, 5, v250
  v_lshlrev_b32 v154, 5, v154
  v_and_b32 v155, 31, v250
  s_nop 3
  v_pk_mul_f32 v[148:149], v[32:33], s[64:65]
  v_pk_mul_f32 v[150:151], v[34:35], s[64:65]
  v_exp_f32_e64 v148, v148 clamp
  v_exp_f32_e64 v149, v149 clamp
  v_exp_f32_e64 v150, v150 clamp
  v_exp_f32_e64 v151, v151 clamp
  v_max_f32 v32, 0, v32
  v_max_f32 v33, 0, v33
  v_max_f32 v34, 0, v34
  v_max_f32 v35, 0, v35
  v_pk_add_f32 v[32:33], v[32:33], v[148:149]
  v_pk_add_f32 v[34:35], v[34:35], v[150:151]
  v_pk_add_f32 v[32:33], v[32:33], s[66:67]
  v_pk_add_f32 v[34:35], v[34:35], s[66:67]
  v_cvt_pk_bf16_f32 v96, v32, v33
  v_cvt_pk_bf16_f32 v97, v34, v35
  v_pk_mul_f32 v[148:149], v[36:37], s[64:65]
  v_pk_mul_f32 v[150:151], v[38:39], s[64:65]
  v_exp_f32_e64 v148, v148 clamp
  v_exp_f32_e64 v149, v149 clamp
  v_exp_f32_e64 v150, v150 clamp
  v_exp_f32_e64 v151, v151 clamp
  v_max_f32 v36, 0, v36
  v_max_f32 v37, 0, v37
  v_max_f32 v38, 0, v38
  v_max_f32 v39, 0, v39
  v_pk_add_f32 v[36:37], v[36:37], v[148:149]
  v_pk_add_f32 v[38:39], v[38:39], v[150:151]
  v_pk_add_f32 v[36:37], v[36:37], s[66:67]
  v_pk_add_f32 v[38:39], v[38:39], s[66:67]
  v_cvt_pk_bf16_f32 v98, v36, v37
  v_cvt_pk_bf16_f32 v99, v38, v39
  v_pk_mul_f32 v[148:149], v[40:41], s[64:65]
  v_pk_mul_f32 v[150:151], v[42:43], s[64:65]
  v_exp_f32_e64 v148, v148 clamp
  v_exp_f32_e64 v149, v149 clamp
  v_exp_f32_e64 v150, v150 clamp
  v_exp_f32_e64 v151, v151 clamp
  v_max_f32 v40, 0, v40
  v_max_f32 v41, 0, v41
  v_max_f32 v42, 0, v42
  v_max_f32 v43, 0, v43
  v_pk_add_f32 v[40:41], v[40:41], v[148:149]
  v_pk_add_f32 v[42:43], v[42:43], v[150:151]
  v_pk_add_f32 v[40:41], v[40:41], s[66:67]
  v_pk_add_f32 v[42:43], v[42:43], s[66:67]
  v_cvt_pk_bf16_f32 v100, v40, v41
  v_cvt_pk_bf16_f32 v101, v42, v43
  v_pk_mul_f32 v[148:149], v[44:45], s[64:65]
  v_pk_mul_f32 v[150:151], v[46:47], s[64:65]
  v_exp_f32_e64 v148, v148 clamp
  v_exp_f32_e64 v149, v149 clamp
  v_exp_f32_e64 v150, v150 clamp
  v_exp_f32_e64 v151, v151 clamp
  v_max_f32 v44, 0, v44
  v_max_f32 v45, 0, v45
  v_max_f32 v46, 0, v46
  v_max_f32 v47, 0, v47
  v_pk_add_f32 v[44:45], v[44:45], v[148:149]
  v_pk_add_f32 v[46:47], v[46:47], v[150:151]
  v_pk_add_f32 v[44:45], v[44:45], s[66:67]
  v_pk_add_f32 v[46:47], v[46:47], s[66:67]
  v_cvt_pk_bf16_f32 v102, v44, v45
  v_cvt_pk_bf16_f32 v103, v46, v47
  v_pk_mul_f32 v[148:149], v[48:49], s[64:65]
  v_pk_mul_f32 v[150:151], v[50:51], s[64:65]
  v_exp_f32_e64 v148, v148 clamp
  v_exp_f32_e64 v149, v149 clamp
  v_exp_f32_e64 v150, v150 clamp
  v_exp_f32_e64 v151, v151 clamp
  v_max_f32 v48, 0, v48
  v_max_f32 v49, 0, v49
  v_max_f32 v50, 0, v50
  v_max_f32 v51, 0, v51
  v_pk_add_f32 v[48:49], v[48:49], v[148:149]
  v_pk_add_f32 v[50:51], v[50:51], v[150:151]
  v_pk_add_f32 v[48:49], v[48:49], s[66:67]
  v_pk_add_f32 v[50:51], v[50:51], s[66:67]
  v_cvt_pk_bf16_f32 v104, v48, v49
  v_cvt_pk_bf16_f32 v105, v50, v51
  v_pk_mul_f32 v[148:149], v[52:53], s[64:65]
  v_pk_mul_f32 v[150:151], v[54:55], s[64:65]
  v_exp_f32_e64 v148, v148 clamp
  v_exp_f32_e64 v149, v149 clamp
  v_exp_f32_e64 v150, v150 clamp
  v_exp_f32_e64 v151, v151 clamp
  v_max_f32 v52, 0, v52
  v_max_f32 v53, 0, v53
  v_max_f32 v54, 0, v54
  v_max_f32 v55, 0, v55
  v_pk_add_f32 v[52:53], v[52:53], v[148:149]
  v_pk_add_f32 v[54:55], v[54:55], v[150:151]
  v_pk_add_f32 v[52:53], v[52:53], s[66:67]
  v_pk_add_f32 v[54:55], v[54:55], s[66:67]
  v_cvt_pk_bf16_f32 v106, v52, v53
  v_cvt_pk_bf16_f32 v107, v54, v55
  v_pk_mul_f32 v[148:149], v[56:57], s[64:65]
  v_pk_mul_f32 v[150:151], v[58:59], s[64:65]
  v_exp_f32_e64 v148, v148 clamp
  v_exp_f32_e64 v149, v149 clamp
  v_exp_f32_e64 v150, v150 clamp
  v_exp_f32_e64 v151, v151 clamp
  v_max_f32 v56, 0, v56
  v_max_f32 v57, 0, v57
  v_max_f32 v58, 0, v58
  v_max_f32 v59, 0, v59
  v_pk_add_f32 v[56:57], v[56:57], v[148:149]
  v_pk_add_f32 v[58:59], v[58:59], v[150:151]
  v_pk_add_f32 v[56:57], v[56:57], s[66:67]
  v_pk_add_f32 v[58:59], v[58:59], s[66:67]
  v_cvt_pk_bf16_f32 v108, v56, v57
  v_cvt_pk_bf16_f32 v109, v58, v59
  v_pk_mul_f32 v[148:149], v[60:61], s[64:65]
  v_pk_mul_f32 v[150:151], v[62:63], s[64:65]
  v_exp_f32_e64 v148, v148 clamp
  v_exp_f32_e64 v149, v149 clamp
  v_exp_f32_e64 v150, v150 clamp
  v_exp_f32_e64 v151, v151 clamp
  v_max_f32 v60, 0, v60
  v_max_f32 v61, 0, v61
  v_max_f32 v62, 0, v62
  v_max_f32 v63, 0, v63
  v_pk_add_f32 v[60:61], v[60:61], v[148:149]
  v_pk_add_f32 v[62:63], v[62:63], v[150:151]
  v_pk_add_f32 v[60:61], v[60:61], s[66:67]
  v_pk_add_f32 v[62:63], v[62:63], s[66:67]
  v_cvt_pk_bf16_f32 v110, v60, v61
  v_cvt_pk_bf16_f32 v111, v62, v63
  v_cvt_pk_bf16_f32 v112, v64, v65
  v_cvt_pk_bf16_f32 v113, v66, v67
  v_cvt_pk_bf16_f32 v114, v68, v69
  v_cvt_pk_bf16_f32 v115, v70, v71
  v_cvt_pk_bf16_f32 v116, v72, v73
  v_cvt_pk_bf16_f32 v117, v74, v75
  v_cvt_pk_bf16_f32 v118, v76, v77
  v_cvt_pk_bf16_f32 v119, v78, v79
  v_cvt_pk_bf16_f32 v120, v80, v81
  v_cvt_pk_bf16_f32 v121, v82, v83
  v_cvt_pk_bf16_f32 v122, v84, v85
  v_cvt_pk_bf16_f32 v123, v86, v87
  v_cvt_pk_bf16_f32 v124, v88, v89
  v_cvt_pk_bf16_f32 v125, v90, v91
  v_cvt_pk_bf16_f32 v126, v92, v93
  v_cvt_pk_bf16_f32 v127, v94, v95
  s_nop 1
  v_mfma_f32_32x32x16_bf16 v[64:79], v[96:99], v[112:115], 0
  v_mfma_f32_32x32x16_bf16 v[80:95], v[96:99], v[128:131], 0
  v_mfma_f32_32x32x16_bf16 v[64:79], v[100:103], v[116:119], v[64:79]
  v_mfma_f32_32x32x16_bf16 v[80:95], v[100:103], v[128:131], v[80:95]
  v_mfma_f32_32x32x16_bf16 v[64:79], v[104:107], v[120:123], v[64:79]
  v_mfma_f32_32x32x16_bf16 v[80:95], v[104:107], v[128:131], v[80:95]
  v_mfma_f32_32x32x16_bf16 v[64:79], v[108:111], v[124:127], v[64:79]
  v_mfma_f32_32x32x16_bf16 v[80:95], v[108:111], v[128:131], v[80:95]
  s_add_u32 s57, s56, 4096
  v_add_u32 v156, s57, v154
  v_cmp_eq_u32 vcc, 0, v155
  s_mov_b64 s[60:61], vcc
  s_nop 7
  s_nop 3
  s_cmp_eq_u32 s52, 0
  s_cbranch_scc1 L_red0
  ds_write_b128 v153, v[64:67] offset:0
  ds_write_b128 v153, v[68:71] offset:1024
  ds_write_b128 v153, v[72:75] offset:2048
  ds_write_b128 v153, v[76:79] offset:3072
  s_mov_b64 exec, s[60:61]
  ds_write_b128 v156, v[80:83] offset:0
  ds_write_b128 v156, v[84:87] offset:16
  ds_write_b128 v156, v[88:91] offset:64
  ds_write_b128 v156, v[92:95] offset:80
  s_mov_b64 exec, -1
  s_lshl_b32 s58, s53, 2
  s_add_u32 s58, s58, 160528
  v_mov_b32 v157, s58
  v_mov_b32 v158, s51
  s_waitcnt lgkmcnt(0)
  ds_write_b32 v157, v158
  s_branch L_phiq
L_red0:
  s_lshl_b32 s58, s49, 4
  s_add_u32 s58, s58, s48
  s_mul_i32 s58, s58, 4352
  s_add_u32 s58, s58, 12648448
  s_lshl_b32 s59, s53, 11
  s_add_u32 s59, s59, s58
  s_lshl_b32 s57, s53, 7
  s_add_u32 s58, s58, s57
  s_add_u32 s58, s58, 4096
  s_lshl_b32 s57, s53, 2
  s_add_u32 s57, s57, 160528
  v_mov_b32 v157, s57
  s_mov_b32 s63, 160000
L_x1:
  ds_read_b32 v158, v157
  s_waitcnt lgkmcnt(0)
  v_cmp_ne_u32 vcc, s51, v158
  s_cbranch_vccz L_x1d
  s_sub_u32 s63, s63, 1
  s_cbranch_scc0 L_x1
L_x1d:
  ds_read_b128 v[32:35], v153 offset:0
  ds_read_b128 v[36:39], v153 offset:1024
  ds_read_b128 v[40:43], v153 offset:2048
  ds_read_b128 v[44:47], v153 offset:3072
  ds_read_b128 v[48:51], v156 offset:0
  ds_read_b128 v[52:55], v156 offset:16
  ds_read_b128 v[56:59], v156 offset:64
  ds_read_b128 v[60:63], v156 offset:80
  s_waitcnt lgkmcnt(4)
  v_pk_add_f32 v[64:65], v[64:65], v[32:33]
  v_pk_add_f32 v[66:67], v[66:67], v[34:35]
  v_pk_add_f32 v[68:69], v[68:69], v[36:37]
  v_pk_add_f32 v[70:71], v[70:71], v[38:39]
  v_pk_add_f32 v[72:73], v[72:73], v[40:41]
  v_pk_add_f32 v[74:75], v[74:75], v[42:43]
  v_pk_add_f32 v[76:77], v[76:77], v[44:45]
  v_pk_add_f32 v[78:79], v[78:79], v[46:47]
  v_cvt_pk_bf16_f32 v32, v64, v65
  v_cvt_pk_bf16_f32 v33, v66, v67
  v_cvt_pk_bf16_f32 v34, v68, v69
  v_cvt_pk_bf16_f32 v35, v70, v71
  v_cvt_pk_bf16_f32 v36, v72, v73
  v_cvt_pk_bf16_f32 v37, v74, v75
  v_cvt_pk_bf16_f32 v38, v76, v77
  v_cvt_pk_bf16_f32 v39, v78, v79
  s_waitcnt lgkmcnt(0)
  buffer_store_dwordx4 v[32:35], v152, s[12:15], s59 offen offset:0 sc1
  buffer_store_dwordx4 v[36:39], v152, s[12:15], s59 offen offset:1024 sc1
  v_pk_add_f32 v[80:81], v[80:81], v[48:49]
  v_pk_add_f32 v[82:83], v[82:83], v[50:51]
  v_pk_add_f32 v[84:85], v[84:85], v[52:53]
  v_pk_add_f32 v[86:87], v[86:87], v[54:55]
  v_pk_add_f32 v[88:89], v[88:89], v[56:57]
  v_pk_add_f32 v[90:91], v[90:91], v[58:59]
  v_pk_add_f32 v[92:93], v[92:93], v[60:61]
  v_pk_add_f32 v[94:95], v[94:95], v[62:63]
  s_mov_b64 exec, s[60:61]
  buffer_store_dwordx4 v[80:83], v154, s[12:15], s58 offen offset:0 sc1
  buffer_store_dwordx4 v[84:87], v154, s[12:15], s58 offen offset:16 sc1
  buffer_store_dwordx4 v[88:91], v154, s[12:15], s58 offen offset:64 sc1
  buffer_store_dwordx4 v[92:95], v154, s[12:15], s58 offen offset:80 sc1
  s_mov_b64 exec, -1
L_phiq:
  v_pk_mul_f32 v[148:149], v[0:1], s[64:65]
  v_pk_mul_f32 v[150:151], v[2:3], s[64:65]
  v_exp_f32_e64 v148, v148 clamp
  v_exp_f32_e64 v149, v149 clamp
  v_exp_f32_e64 v150, v150 clamp
  v_exp_f32_e64 v151, v151 clamp
  v_max_f32 v0, 0, v0
  v_max_f32 v1, 0, v1
  v_max_f32 v2, 0, v2
  v_max_f32 v3, 0, v3
  v_pk_add_f32 v[0:1], v[0:1], v[148:149]
  v_pk_add_f32 v[2:3], v[2:3], v[150:151]
  v_pk_add_f32 v[0:1], v[0:1], s[66:67]
  v_pk_add_f32 v[2:3], v[2:3], s[66:67]
  v_cvt_pk_bf16_f32 v132, v0, v1
  v_cvt_pk_bf16_f32 v133, v2, v3
  v_pk_mul_f32 v[148:149], v[4:5], s[64:65]
  v_pk_mul_f32 v[150:151], v[6:7], s[64:65]
  v_exp_f32_e64 v148, v148 clamp
  v_exp_f32_e64 v149, v149 clamp
  v_exp_f32_e64 v150, v150 clamp
  v_exp_f32_e64 v151, v151 clamp
  v_max_f32 v4, 0, v4
  v_max_f32 v5, 0, v5
  v_max_f32 v6, 0, v6
  v_max_f32 v7, 0, v7
  v_pk_add_f32 v[4:5], v[4:5], v[148:149]
  v_pk_add_f32 v[6:7], v[6:7], v[150:151]
  v_pk_add_f32 v[4:5], v[4:5], s[66:67]
  v_pk_add_f32 v[6:7], v[6:7], s[66:67]
  v_cvt_pk_bf16_f32 v134, v4, v5
  v_cvt_pk_bf16_f32 v135, v6, v7
  v_pk_mul_f32 v[148:149], v[8:9], s[64:65]
  v_pk_mul_f32 v[150:151], v[10:11], s[64:65]
  v_exp_f32_e64 v148, v148 clamp
  v_exp_f32_e64 v149, v149 clamp
  v_exp_f32_e64 v150, v150 clamp
  v_exp_f32_e64 v151, v151 clamp
  v_max_f32 v8, 0, v8
  v_max_f32 v9, 0, v9
  v_max_f32 v10, 0, v10
  v_max_f32 v11, 0, v11
  v_pk_add_f32 v[8:9], v[8:9], v[148:149]
  v_pk_add_f32 v[10:11], v[10:11], v[150:151]
  v_pk_add_f32 v[8:9], v[8:9], s[66:67]
  v_pk_add_f32 v[10:11], v[10:11], s[66:67]
  v_cvt_pk_bf16_f32 v136, v8, v9
  v_cvt_pk_bf16_f32 v137, v10, v11
  v_pk_mul_f32 v[148:149], v[12:13], s[64:65]
  v_pk_mul_f32 v[150:151], v[14:15], s[64:65]
  v_exp_f32_e64 v148, v148 clamp
  v_exp_f32_e64 v149, v149 clamp
  v_exp_f32_e64 v150, v150 clamp
  v_exp_f32_e64 v151, v151 clamp
  v_max_f32 v12, 0, v12
  v_max_f32 v13, 0, v13
  v_max_f32 v14, 0, v14
  v_max_f32 v15, 0, v15
  v_pk_add_f32 v[12:13], v[12:13], v[148:149]
  v_pk_add_f32 v[14:15], v[14:15], v[150:151]
  v_pk_add_f32 v[12:13], v[12:13], s[66:67]
  v_pk_add_f32 v[14:15], v[14:15], s[66:67]
  v_cvt_pk_bf16_f32 v138, v12, v13
  v_cvt_pk_bf16_f32 v139, v14, v15
  v_pk_mul_f32 v[148:149], v[16:17], s[64:65]
  v_pk_mul_f32 v[150:151], v[18:19], s[64:65]
  v_exp_f32_e64 v148, v148 clamp
  v_exp_f32_e64 v149, v149 clamp
  v_exp_f32_e64 v150, v150 clamp
  v_exp_f32_e64 v151, v151 clamp
  v_max_f32 v16, 0, v16
  v_max_f32 v17, 0, v17
  v_max_f32 v18, 0, v18
  v_max_f32 v19, 0, v19
  v_pk_add_f32 v[16:17], v[16:17], v[148:149]
  v_pk_add_f32 v[18:19], v[18:19], v[150:151]
  v_pk_add_f32 v[16:17], v[16:17], s[66:67]
  v_pk_add_f32 v[18:19], v[18:19], s[66:67]
  v_cvt_pk_bf16_f32 v140, v16, v17
  v_cvt_pk_bf16_f32 v141, v18, v19
  v_pk_mul_f32 v[148:149], v[20:21], s[64:65]
  v_pk_mul_f32 v[150:151], v[22:23], s[64:65]
  v_exp_f32_e64 v148, v148 clamp
  v_exp_f32_e64 v149, v149 clamp
  v_exp_f32_e64 v150, v150 clamp
  v_exp_f32_e64 v151, v151 clamp
  v_max_f32 v20, 0, v20
  v_max_f32 v21, 0, v21
  v_max_f32 v22, 0, v22
  v_max_f32 v23, 0, v23
  v_pk_add_f32 v[20:21], v[20:21], v[148:149]
  v_pk_add_f32 v[22:23], v[22:23], v[150:151]
  v_pk_add_f32 v[20:21], v[20:21], s[66:67]
  v_pk_add_f32 v[22:23], v[22:23], s[66:67]
  v_cvt_pk_bf16_f32 v142, v20, v21
  v_cvt_pk_bf16_f32 v143, v22, v23
  v_pk_mul_f32 v[148:149], v[24:25], s[64:65]
  v_pk_mul_f32 v[150:151], v[26:27], s[64:65]
  v_exp_f32_e64 v148, v148 clamp
  v_exp_f32_e64 v149, v149 clamp
  v_exp_f32_e64 v150, v150 clamp
  v_exp_f32_e64 v151, v151 clamp
  v_max_f32 v24, 0, v24
  v_max_f32 v25, 0, v25
  v_max_f32 v26, 0, v26
  v_max_f32 v27, 0, v27
  v_pk_add_f32 v[24:25], v[24:25], v[148:149]
  v_pk_add_f32 v[26:27], v[26:27], v[150:151]
  v_pk_add_f32 v[24:25], v[24:25], s[66:67]
  v_pk_add_f32 v[26:27], v[26:27], s[66:67]
  v_cvt_pk_bf16_f32 v144, v24, v25
  v_cvt_pk_bf16_f32 v145, v26, v27
  v_pk_mul_f32 v[148:149], v[28:29], s[64:65]
  v_pk_mul_f32 v[150:151], v[30:31], s[64:65]
  v_exp_f32_e64 v148, v148 clamp
  v_exp_f32_e64 v149, v149 clamp
  v_exp_f32_e64 v150, v150 clamp
  v_exp_f32_e64 v151, v151 clamp
  v_max_f32 v28, 0, v28
  v_max_f32 v29, 0, v29
  v_max_f32 v30, 0, v30
  v_max_f32 v31, 0, v31
  v_pk_add_f32 v[28:29], v[28:29], v[148:149]
  v_pk_add_f32 v[30:31], v[30:31], v[150:151]
  v_pk_add_f32 v[28:29], v[28:29], s[66:67]
  v_pk_add_f32 v[30:31], v[30:31], s[66:67]
  v_cvt_pk_bf16_f32 v146, v28, v29
  v_cvt_pk_bf16_f32 v147, v30, v31
  s_lshl_b32 s56, s50, 12
  s_add_u32 s56, s56, 92160
  v_add_u32 v153, s56, v152
  ds_write_b128 v153, v[132:135] offset:0
  ds_write_b128 v153, v[136:139] offset:1024
  ds_write_b128 v153, v[140:143] offset:2048
  ds_write_b128 v153, v[144:147] offset:3072
  s_cmp_lg_u32 s52, 0
  s_cbranch_scc1 L_nof2
  s_lshl_b32 s56, s49, 7
  s_lshl_b32 s57, s48, 3
  s_add_u32 s56, s56, s57
  s_lshl_b32 s57, s53, 2
  s_add_u32 s56, s56, s57
  s_add_u32 s56, s56, 8192
  s_waitcnt vmcnt(0)
  v_mov_b32 v157, 0
  v_mov_b32 v158, s51
  s_mov_b64 exec, 1
  buffer_store_dword v158, v157, s[12:15], s56 offen sc1
  s_mov_b64 exec, -1
L_nof2:
  v_and_b32 v175, 15, v250
  v_lshrrev_b32 v176, 4, v250
  v_add_u32 v177, 1, v175
  v_and_b32 v177, -2, v177
  v_lshlrev_b32 v177, 1, v177
  v_lshl_add_u32 v177, v176, 4, v177
  v_and_b32 v178, 1, v175
  v_xor_b32 v178, 1, v178
  v_mul_u32_u24 v178, 4160, v178
  v_add_u32 v177, v177, v178
  s_mul_i32 s56, s50, 8320
  s_add_u32 s56, s56, 123328
  v_add_u32 v160, s56, v177
  v_add_u32 v161, 512, v160
  v_add_u32 v162, 1024, v160
  v_add_u32 v163, 1536, v160
  v_add_u32 v164, 2048, v160
  v_add_u32 v165, 2560, v160
  v_add_u32 v166, 3072, v160
  v_add_u32 v167, 3584, v160
  v_lshlrev_b32 v168, 4, v176
  v_lshlrev_b32 v177, 5, v175
  v_sub_u32 v168, v168, v177
  s_mul_i32 s56, s50, 4576
  s_add_u32 s56, s56, 74656
  v_add_u32 v168, s56, v168
  v_mov_b32 v0, 0
  v_mov_b32 v1, 0
  v_mov_b32 v2, 0
  v_mov_b32 v3, 0
  v_mov_b32 v4, 0
  v_mov_b32 v5, 0
  v_mov_b32 v6, 0
  v_mov_b32 v7, 0
  v_mov_b32 v8, 0
  v_mov_b32 v9, 0
  v_mov_b32 v10, 0
  v_mov_b32 v11, 0
  v_mov_b32 v12, 0
  v_mov_b32 v13, 0
  v_mov_b32 v14, 0
  v_mov_b32 v15, 0
  v_mov_b32 v16, 0
  v_mov_b32 v17, 0
  v_mov_b32 v18, 0
  v_mov_b32 v19, 0
  v_mov_b32 v20, 0
  v_mov_b32 v21, 0
  v_mov_b32 v22, 0
  v_mov_b32 v23, 0
  v_mov_b32 v24, 0
  v_mov_b32 v25, 0
  v_mov_b32 v26, 0
  v_mov_b32 v27, 0
  v_mov_b32 v28, 0
  v_mov_b32 v29, 0
  v_mov_b32 v30, 0
  v_mov_b32 v31, 0
  v_lshlrev_b32 v179, 11, v250
  s_lshl_b32 s56, s48, 18
  s_lshl_b32 s57, s49, 7
  s_add_u32 s56, s56, s57
  s_and_b32 s57, s50, 1
  s_lshl_b32 s57, s57, 17
  s_add_u32 s56, s56, s57
  s_cmp_lt_u32 s50, 2
  s_cbranch_scc0 L_noqpf
  buffer_load_dword v251, v179, s[44:47], s56 offen
L_noqpf:
  v_lshrrev_b32 v179, 3, v250
  v_lshlrev_b32 v179, 11, v179
  v_lshrrev_b32 v180, 4, v250
  v_and_b32 v180, 1, v180
  v_lshlrev_b32 v180, 2, v180
  v_and_b32 v181, 7, v250
  v_xor_b32 v180, v180, v181
  v_lshl_add_u32 v179, v180, 4, v179
  s_lshl_b32 s56, s55, 7
  v_add_u32 v244, s56, v179
  v_add_u32 v245, 15360, v244
  v_add_u32 v246, 30720, v244
  v_add_u32 v247, 46080, v244
  s_waitcnt lgkmcnt(0)
  s_barrier
  s_setprio 1
  ds_read2_b32 v[32:33], v160 offset0:0 offset1:1
  ds_read2_b32 v[34:35], v160 offset0:2 offset1:3
  ds_read_b128 v[64:67], v168 offset:3584
  ds_read2_b32 v[36:37], v161 offset0:0 offset1:1
  ds_read2_b32 v[38:39], v161 offset0:2 offset1:3
  ds_read_b128 v[68:71], v168 offset:3072
  ds_read2_b32 v[40:41], v162 offset0:0 offset1:1
  ds_read2_b32 v[42:43], v162 offset0:2 offset1:3
  ds_read_b128 v[72:75], v168 offset:2560
  ds_read2_b32 v[44:45], v163 offset0:0 offset1:1
  ds_read2_b32 v[46:47], v163 offset0:2 offset1:3
  ds_read_b128 v[76:79], v168 offset:2048
  s_waitcnt lgkmcnt(4)
  ds_read2_b32 v[48:49], v164 offset0:0 offset1:1
  ds_read2_b32 v[50:51], v164 offset0:2 offset1:3
  ds_read_b128 v[80:83], v168 offset:1536
  ds_read2_b32 v[52:53], v165 offset0:0 offset1:1
  ds_read2_b32 v[54:55], v165 offset0:2 offset1:3
  ds_read_b128 v[84:87], v168 offset:1024
  ds_read2_b32 v[56:57], v166 offset0:0 offset1:1
  ds_read2_b32 v[58:59], v166 offset0:2 offset1:3
  s_waitcnt lgkmcnt(4)
  ds_read_b128 v[88:91], v168 offset:512
  ds_read2_b32 v[60:61], v167 offset0:0 offset1:1
  ds_read2_b32 v[62:63], v167 offset0:2 offset1:3
  ds_read_b128 v[92:95], v168 offset:0
  v_subrev_u32 v160, 64, v160
  v_subrev_u32 v161, 64, v161
  v_subrev_u32 v162, 64, v162
  v_subrev_u32 v163, 64, v163
  v_subrev_u32 v164, 64, v164
  v_subrev_u32 v165, 64, v165
  v_subrev_u32 v166, 64, v166
  v_subrev_u32 v167, 64, v167
  v_subrev_u32 v168, 64, v168
  s_mov_b32 s69, 4
L_cloop:
  s_waitcnt lgkmcnt(0)
  v_mfma_f32_16x16x32_bf16 v[0:3], v[32:35], v[64:67], v[0:3]
  ds_read2_b32 v[96:97], v160 offset0:0 offset1:1
  v_mfma_f32_16x16x32_bf16 v[4:7], v[32:35], v[68:71], v[4:7]
  ds_read2_b32 v[98:99], v160 offset0:2 offset1:3
  v_mfma_f32_16x16x32_bf16 v[4:7], v[36:39], v[64:67], v[4:7]
  ds_read_b128 v[128:131], v168 offset:3584
  v_mfma_f32_16x16x32_bf16 v[8:11], v[36:39], v[68:71], v[8:11]
  v_mfma_f32_16x16x32_bf16 v[8:11], v[32:35], v[72:75], v[8:11]
  ds_read2_b32 v[100:101], v161 offset0:0 offset1:1
  v_mfma_f32_16x16x32_bf16 v[12:15], v[36:39], v[72:75], v[12:15]
  ds_read2_b32 v[102:103], v161 offset0:2 offset1:3
  v_mfma_f32_16x16x32_bf16 v[8:11], v[40:43], v[64:67], v[8:11]
  ds_read_b128 v[132:135], v168 offset:3072
  v_mfma_f32_16x16x32_bf16 v[12:15], v[40:43], v[68:71], v[12:15]
  v_mfma_f32_16x16x32_bf16 v[16:19], v[40:43], v[72:75], v[16:19]
  ds_read2_b32 v[104:105], v162 offset0:0 offset1:1
  v_mfma_f32_16x16x32_bf16 v[12:15], v[32:35], v[76:79], v[12:15]
  ds_read2_b32 v[106:107], v162 offset0:2 offset1:3
  v_mfma_f32_16x16x32_bf16 v[16:19], v[36:39], v[76:79], v[16:19]
  ds_read_b128 v[136:139], v168 offset:2560
  v_mfma_f32_16x16x32_bf16 v[20:23], v[40:43], v[76:79], v[20:23]
  v_mfma_f32_16x16x32_bf16 v[12:15], v[44:47], v[64:67], v[12:15]
  ds_read2_b32 v[108:109], v163 offset0:0 offset1:1
  v_mfma_f32_16x16x32_bf16 v[16:19], v[44:47], v[68:71], v[16:19]
  ds_read2_b32 v[110:111], v163 offset0:2 offset1:3
  v_mfma_f32_16x16x32_bf16 v[20:23], v[44:47], v[72:75], v[20:23]
  ds_read_b128 v[140:143], v168 offset:2048
  v_mfma_f32_16x16x32_bf16 v[24:27], v[44:47], v[76:79], v[24:27]
  v_mfma_f32_16x16x32_bf16 v[16:19], v[32:35], v[80:83], v[16:19]
  ds_read2_b32 v[112:113], v164 offset0:0 offset1:1
  v_mfma_f32_16x16x32_bf16 v[20:23], v[36:39], v[80:83], v[20:23]
  ds_read2_b32 v[114:115], v164 offset0:2 offset1:3
  v_mfma_f32_16x16x32_bf16 v[24:27], v[40:43], v[80:83], v[24:27]
  ds_read_b128 v[144:147], v168 offset:1536
  v_mfma_f32_16x16x32_bf16 v[28:31], v[44:47], v[80:83], v[28:31]
  v_mfma_f32_16x16x32_bf16 v[16:19], v[48:51], v[64:67], v[16:19]
  ds_read2_b32 v[116:117], v165 offset0:0 offset1:1
  v_mfma_f32_16x16x32_bf16 v[20:23], v[48:51], v[68:71], v[20:23]
  ds_read2_b32 v[118:119], v165 offset0:2 offset1:3
  v_mfma_f32_16x16x32_bf16 v[24:27], v[48:51], v[72:75], v[24:27]
  ds_read_b128 v[148:151], v168 offset:1024
  v_mfma_f32_16x16x32_bf16 v[28:31], v[48:51], v[76:79], v[28:31]
  v_mfma_f32_16x16x32_bf16 v[20:23], v[32:35], v[84:87], v[20:23]
  ds_read2_b32 v[120:121], v166 offset0:0 offset1:1
  v_mfma_f32_16x16x32_bf16 v[24:27], v[36:39], v[84:87], v[24:27]
  ds_read2_b32 v[122:123], v166 offset0:2 offset1:3
  v_mfma_f32_16x16x32_bf16 v[28:31], v[40:43], v[84:87], v[28:31]
  ds_read_b128 v[152:155], v168 offset:512
  v_mfma_f32_16x16x32_bf16 v[20:23], v[52:55], v[64:67], v[20:23]
  v_mfma_f32_16x16x32_bf16 v[24:27], v[52:55], v[68:71], v[24:27]
  ds_read2_b32 v[124:125], v167 offset0:0 offset1:1
  v_mfma_f32_16x16x32_bf16 v[28:31], v[52:55], v[72:75], v[28:31]
  ds_read2_b32 v[126:127], v167 offset0:2 offset1:3
  v_mfma_f32_16x16x32_bf16 v[24:27], v[32:35], v[88:91], v[24:27]
  ds_read_b128 v[156:159], v168 offset:0
  v_mfma_f32_16x16x32_bf16 v[28:31], v[36:39], v[88:91], v[28:31]
  v_mfma_f32_16x16x32_bf16 v[24:27], v[56:59], v[64:67], v[24:27]
  v_mfma_f32_16x16x32_bf16 v[28:31], v[56:59], v[68:71], v[28:31]
  v_subrev_u32 v160, 64, v160
  v_subrev_u32 v161, 64, v161
  v_subrev_u32 v162, 64, v162
  v_subrev_u32 v163, 64, v163
  v_subrev_u32 v164, 64, v164
  v_subrev_u32 v165, 64, v165
  v_subrev_u32 v166, 64, v166
  v_subrev_u32 v167, 64, v167
  v_subrev_u32 v168, 64, v168
  v_mfma_f32_16x16x32_bf16 v[28:31], v[32:35], v[92:95], v[28:31]
  v_mfma_f32_16x16x32_bf16 v[28:31], v[60:63], v[64:67], v[28:31]
  s_waitcnt lgkmcnt(0)
  v_mfma_f32_16x16x32_bf16 v[0:3], v[96:99], v[128:131], v[0:3]
  ds_read2_b32 v[32:33], v160 offset0:0 offset1:1
  v_mfma_f32_16x16x32_bf16 v[4:7], v[96:99], v[132:135], v[4:7]
  ds_read2_b32 v[34:35], v160 offset0:2 offset1:3
  v_mfma_f32_16x16x32_bf16 v[4:7], v[100:103], v[128:131], v[4:7]
  ds_read_b128 v[64:67], v168 offset:3584
  v_mfma_f32_16x16x32_bf16 v[8:11], v[100:103], v[132:135], v[8:11]
  v_mfma_f32_16x16x32_bf16 v[8:11], v[96:99], v[136:139], v[8:11]
  ds_read2_b32 v[36:37], v161 offset0:0 offset1:1
  v_mfma_f32_16x16x32_bf16 v[12:15], v[100:103], v[136:139], v[12:15]
  ds_read2_b32 v[38:39], v161 offset0:2 offset1:3
  v_mfma_f32_16x16x32_bf16 v[8:11], v[104:107], v[128:131], v[8:11]
  ds_read_b128 v[68:71], v168 offset:3072
  v_mfma_f32_16x16x32_bf16 v[12:15], v[104:107], v[132:135], v[12:15]
  v_mfma_f32_16x16x32_bf16 v[16:19], v[104:107], v[136:139], v[16:19]
  ds_read2_b32 v[40:41], v162 offset0:0 offset1:1
  v_mfma_f32_16x16x32_bf16 v[12:15], v[96:99], v[140:143], v[12:15]
  ds_read2_b32 v[42:43], v162 offset0:2 offset1:3
  v_mfma_f32_16x16x32_bf16 v[16:19], v[100:103], v[140:143], v[16:19]
  ds_read_b128 v[72:75], v168 offset:2560
  v_mfma_f32_16x16x32_bf16 v[20:23], v[104:107], v[140:143], v[20:23]
  v_mfma_f32_16x16x32_bf16 v[12:15], v[108:111], v[128:131], v[12:15]
  ds_read2_b32 v[44:45], v163 offset0:0 offset1:1
  v_mfma_f32_16x16x32_bf16 v[16:19], v[108:111], v[132:135], v[16:19]
  ds_read2_b32 v[46:47], v163 offset0:2 offset1:3
  v_mfma_f32_16x16x32_bf16 v[20:23], v[108:111], v[136:139], v[20:23]
  ds_read_b128 v[76:79], v168 offset:2048
  v_mfma_f32_16x16x32_bf16 v[24:27], v[108:111], v[140:143], v[24:27]
  v_mfma_f32_16x16x32_bf16 v[16:19], v[96:99], v[144:147], v[16:19]
  ds_read2_b32 v[48:49], v164 offset0:0 offset1:1
  v_mfma_f32_16x16x32_bf16 v[20:23], v[100:103], v[144:147], v[20:23]
  ds_read2_b32 v[50:51], v164 offset0:2 offset1:3
  v_mfma_f32_16x16x32_bf16 v[24:27], v[104:107], v[144:147], v[24:27]
  ds_read_b128 v[80:83], v168 offset:1536
  v_mfma_f32_16x16x32_bf16 v[28:31], v[108:111], v[144:147], v[28:31]
  v_mfma_f32_16x16x32_bf16 v[16:19], v[112:115], v[128:131], v[16:19]
  ds_read2_b32 v[52:53], v165 offset0:0 offset1:1
  v_mfma_f32_16x16x32_bf16 v[20:23], v[112:115], v[132:135], v[20:23]
  ds_read2_b32 v[54:55], v165 offset0:2 offset1:3
  v_mfma_f32_16x16x32_bf16 v[24:27], v[112:115], v[136:139], v[24:27]
  ds_read_b128 v[84:87], v168 offset:1024
  v_mfma_f32_16x16x32_bf16 v[28:31], v[112:115], v[140:143], v[28:31]
  v_mfma_f32_16x16x32_bf16 v[20:23], v[96:99], v[148:151], v[20:23]
  ds_read2_b32 v[56:57], v166 offset0:0 offset1:1
  v_mfma_f32_16x16x32_bf16 v[24:27], v[100:103], v[148:151], v[24:27]
  ds_read2_b32 v[58:59], v166 offset0:2 offset1:3
  v_mfma_f32_16x16x32_bf16 v[28:31], v[104:107], v[148:151], v[28:31]
  ds_read_b128 v[88:91], v168 offset:512
  v_mfma_f32_16x16x32_bf16 v[20:23], v[116:119], v[128:131], v[20:23]
  v_mfma_f32_16x16x32_bf16 v[24:27], v[116:119], v[132:135], v[24:27]
  ds_read2_b32 v[60:61], v167 offset0:0 offset1:1
  v_mfma_f32_16x16x32_bf16 v[28:31], v[116:119], v[136:139], v[28:31]
  ds_read2_b32 v[62:63], v167 offset0:2 offset1:3
  v_mfma_f32_16x16x32_bf16 v[24:27], v[96:99], v[152:155], v[24:27]
  ds_read_b128 v[92:95], v168 offset:0
  v_mfma_f32_16x16x32_bf16 v[28:31], v[100:103], v[152:155], v[28:31]
  v_mfma_f32_16x16x32_bf16 v[24:27], v[120:123], v[128:131], v[24:27]
  v_mfma_f32_16x16x32_bf16 v[28:31], v[120:123], v[132:135], v[28:31]
  v_subrev_u32 v160, 64, v160
  v_subrev_u32 v161, 64, v161
  v_subrev_u32 v162, 64, v162
  v_subrev_u32 v163, 64, v163
  v_subrev_u32 v164, 64, v164
  v_subrev_u32 v165, 64, v165
  v_subrev_u32 v166, 64, v166
  v_subrev_u32 v167, 64, v167
  v_subrev_u32 v168, 64, v168
  v_mfma_f32_16x16x32_bf16 v[28:31], v[96:99], v[156:159], v[28:31]
  v_mfma_f32_16x16x32_bf16 v[28:31], v[124:127], v[128:131], v[28:31]
  s_sub_u32 s69, s69, 1
  s_cmp_lg_u32 s69, 0
  s_cbranch_scc1 L_cloop
  s_waitcnt lgkmcnt(0)
  s_lshl_b32 s62, s50, 2
  s_add_u32 s62, s62, 160576
  v_mov_b32 v175, s62
  v_mov_b32 v176, s51
  ds_write_b32 v175, v176
  s_nop 3
  v_and_b32 v175, 15, v250
  v_lshrrev_b32 v176, 4, v250
  v_lshlrev_b32 v175, 5, v175
  v_and_b32 v177, 1, v176
  v_lshl_add_u32 v175, v177, 9, v175
  v_lshrrev_b32 v176, 1, v176
  v_lshl_add_u32 v175, v176, 4, v175
  s_lshl_b32 s56, s49, 6
  s_lshl_b32 s57, s48, 2
  s_add_u32 s56, s56, s57
  s_add_u32 s56, s56, s50
  s_lshl_b32 s56, s56, 12
  s_add_u32 s56, s56, 4259840
  v_cvt_pk_bf16_f32 v32, v0, v1
  v_cvt_pk_bf16_f32 v33, v2, v3
  v_cvt_pk_bf16_f32 v34, v4, v5
  v_cvt_pk_bf16_f32 v35, v6, v7
  v_cvt_pk_bf16_f32 v36, v8, v9
  v_cvt_pk_bf16_f32 v37, v10, v11
  v_cvt_pk_bf16_f32 v38, v12, v13
  v_cvt_pk_bf16_f32 v39, v14, v15
  v_cvt_pk_bf16_f32 v40, v16, v17
  v_cvt_pk_bf16_f32 v41, v18, v19
  v_cvt_pk_bf16_f32 v42, v20, v21
  v_cvt_pk_bf16_f32 v43, v22, v23
  v_cvt_pk_bf16_f32 v44, v24, v25
  v_cvt_pk_bf16_f32 v45, v26, v27
  v_cvt_pk_bf16_f32 v46, v28, v29
  v_cvt_pk_bf16_f32 v47, v30, v31
  s_nop 1
  v_permlane16_swap_b32 v32, v34
  v_permlane16_swap_b32 v33, v35
  v_permlane16_swap_b32 v36, v38
  v_permlane16_swap_b32 v37, v39
  v_permlane16_swap_b32 v40, v42
  v_permlane16_swap_b32 v41, v43
  v_permlane16_swap_b32 v44, v46
  v_permlane16_swap_b32 v45, v47
  s_nop 1
  buffer_store_dwordx4 v[32:35], v175, s[12:15], s56 offen offset:0 sc1
  buffer_store_dwordx4 v[36:39], v175, s[12:15], s56 offen offset:1024 sc1
  buffer_store_dwordx4 v[40:43], v175, s[12:15], s56 offen offset:2048 sc1
  buffer_store_dwordx4 v[44:47], v175, s[12:15], s56 offen offset:3072 sc1
  v_and_b32 v200, 31, v250
  v_lshlrev_b32 v208, 2, v200
  v_lshlrev_b32 v200, 4, v200
  v_lshrrev_b32 v209, 5, v250
  v_lshl_add_u32 v200, v209, 11, v200
  v_add_u32 v201, 4096, v200
  v_add_u32 v202, 8192, v200
  v_add_u32 v203, 12288, v200
  s_lshl_b32 s64, s54, 18
  s_lshl_b32 s57, s50, 9
  s_add_u32 s64, s64, s57
  s_add_u32 s64, s64, 8454144
  s_lshl_b32 s65, s55, 2
  s_mov_b32 s65, 0
  v_lshrrev_b32 v212, 5, v250
  v_lshlrev_b32 v212, 2, v212
  v_and_b32 v213, 15, v250
  v_lshrrev_b32 v213, 2, v213
  v_add_u32 v212, v212, v213
  v_lshlrev_b32 v212, 7, v212
  v_lshrrev_b32 v213, 4, v250
  v_and_b32 v213, 1, v213
  v_lshlrev_b32 v213, 1, v213
  v_and_b32 v214, 3, v250
  v_lshrrev_b32 v214, 1, v214
  v_add_u32 v213, v213, v214
  v_lshrrev_b32 v214, 3, v250
  v_and_b32 v214, 1, v214
  v_lshlrev_b32 v214, 2, v214
  v_xor_b32 v213, v213, v214
  v_and_b32 v215, 1, v250
  v_lshl_add_u32 v212, v215, 3, v212
  s_lshl_b32 s56, s65, 11
  v_add_u32 v212, s56, v212
  v_lshl_add_u32 v204, v213, 4, v212
  v_xor_b32 v213, 4, v213
  v_lshl_add_u32 v205, v213, 4, v212
  s_lshl_b32 s56, s49, 8
  s_lshl_b32 s57, s48, 4
  s_add_u32 s56, s56, s57
  s_lshl_b32 s57, s50, 2
  s_add_u32 s56, s56, s57
  s_add_u32 s61, s56, 16384
  s_waitcnt vmcnt(0)
  v_mov_b32 v210, 0
  v_mov_b32 v211, s51
  s_mov_b64 exec, 1
  buffer_store_dword v211, v210, s[12:15], s61 offen sc1
  s_mov_b64 exec, -1
  v_and_b32 v210, 3, v250
  v_lshlrev_b32 v210, 2, v210
  v_add_u32 v210, 160624, v210
  s_mov_b32 s63, 160000
w1_4:
  ds_read_b32 v211, v210
  s_waitcnt lgkmcnt(0)
  v_cmp_ne_u32 vcc, s51, v211
  s_cbranch_vccz w1d_5
  s_sub_u32 s63, s63, 1
  s_cbranch_scc0 w1_4
w1d_5:
  s_lshl_b32 s57, s54, 1
  s_lshr_b32 s58, s50, 1
  s_add_u32 s57, s57, s58
  s_lshl_b32 s57, s57, 7
  s_add_u32 s57, s57, 12288
  ds_read_b64_tr_b16 v[32:33], v204 offset:0
  ds_read_b64_tr_b16 v[34:35], v204 offset:1024
  ds_read_b64_tr_b16 v[36:37], v205 offset:0
  ds_read_b64_tr_b16 v[38:39], v205 offset:1024
  ds_read_b64_tr_b16 v[40:41], v204 offset:2048
  ds_read_b64_tr_b16 v[42:43], v204 offset:3072
  ds_read_b64_tr_b16 v[44:45], v205 offset:2048
  ds_read_b64_tr_b16 v[46:47], v205 offset:3072
  s_mov_b32 s63, 20000
pf3_6:
  buffer_load_dword v209, v208, s[12:15], s57 offen sc1
  s_waitcnt vmcnt(0)
  v_cmp_ne_u32 vcc, s51, v209
  s_cbranch_vccz pf3d_7
  s_sub_u32 s63, s63, 1
  s_cbranch_scc1 pf3d_7
  s_sleep 1
  s_branch pf3_6
pf3d_7:
  s_add_u32 s66, s65, 0
  s_and_b32 s66, s66, 63
  s_lshl_b32 s66, s66, 12
  s_add_u32 s66, s66, s64
  buffer_load_dwordx4 v[64:67], v200, s[12:15], s66 offen sc1
  buffer_load_dwordx4 v[68:71], v201, s[12:15], s66 offen sc1
  buffer_load_dwordx4 v[72:75], v202, s[12:15], s66 offen sc1
  buffer_load_dwordx4 v[76:79], v203, s[12:15], s66 offen sc1
  s_add_u32 s66, s65, 4
  s_and_b32 s66, s66, 63
  s_lshl_b32 s66, s66, 12
  s_add_u32 s66, s66, s64
  buffer_load_dwordx4 v[80:83], v200, s[12:15], s66 offen sc1
  buffer_load_dwordx4 v[84:87], v201, s[12:15], s66 offen sc1
  buffer_load_dwordx4 v[88:91], v202, s[12:15], s66 offen sc1
  buffer_load_dwordx4 v[92:95], v203, s[12:15], s66 offen sc1
  s_add_u32 s66, s65, 8
  s_and_b32 s66, s66, 63
  s_lshl_b32 s66, s66, 12
  s_add_u32 s66, s66, s64
  buffer_load_dwordx4 v[96:99], v200, s[12:15], s66 offen sc1
  buffer_load_dwordx4 v[100:103], v201, s[12:15], s66 offen sc1
  buffer_load_dwordx4 v[104:107], v202, s[12:15], s66 offen sc1
  buffer_load_dwordx4 v[108:111], v203, s[12:15], s66 offen sc1
  s_add_u32 s66, s65, 12
  s_and_b32 s66, s66, 63
  s_lshl_b32 s66, s66, 12
  s_add_u32 s66, s66, s64
  buffer_load_dwordx4 v[112:115], v200, s[12:15], s66 offen sc1
  buffer_load_dwordx4 v[116:119], v201, s[12:15], s66 offen sc1
  s_setprio 3
  s_waitcnt vmcnt(13)
  s_waitcnt lgkmcnt(4)
  v_mfma_f32_32x32x16_bf16 v[0:15], v[32:35], v[64:67], 0
  ds_read_b64_tr_b16 v[48:49], v204 offset:4096
  ds_read_b64_tr_b16 v[50:51], v204 offset:5120
  buffer_load_dwordx4 v[120:123], v202, s[12:15], s66 offen sc1
  v_mfma_f32_32x32x16_bf16 v[16:31], v[36:39], v[64:67], 0
  ds_read_b64_tr_b16 v[52:53], v205 offset:4096
  ds_read_b64_tr_b16 v[54:55], v205 offset:5120
  s_waitcnt vmcnt(13)
  s_waitcnt lgkmcnt(4)
  v_mfma_f32_32x32x16_bf16 v[0:15], v[40:43], v[68:71], v[0:15]
  ds_read_b64_tr_b16 v[56:57], v204 offset:6144
  ds_read_b64_tr_b16 v[58:59], v204 offset:7168
  buffer_load_dwordx4 v[124:127], v203, s[12:15], s66 offen sc1
  v_mfma_f32_32x32x16_bf16 v[16:31], v[44:47], v[68:71], v[16:31]
  ds_read_b64_tr_b16 v[60:61], v205 offset:6144
  ds_read_b64_tr_b16 v[62:63], v205 offset:7168
  s_waitcnt vmcnt(13)
  s_waitcnt lgkmcnt(4)
  s_cmp_eq_u32 s65, 60
  s_cselect_b32 s56, 0xfffe0000, 0
  v_add_u32 v204, s56, v204
  v_add_u32 v205, s56, v205
  v_mfma_f32_32x32x16_bf16 v[0:15], v[48:51], v[72:75], v[0:15]
  ds_read_b64_tr_b16 v[32:33], v204 offset:8192
  ds_read_b64_tr_b16 v[34:35], v204 offset:9216
  s_add_u32 s66, s65, 16
  s_and_b32 s66, s66, 63
  s_lshl_b32 s66, s66, 12
  s_add_u32 s66, s66, s64
  buffer_load_dwordx4 v[128:131], v200, s[12:15], s66 offen sc1
  v_mfma_f32_32x32x16_bf16 v[16:31], v[52:55], v[72:75], v[16:31]
  ds_read_b64_tr_b16 v[36:37], v205 offset:8192
  ds_read_b64_tr_b16 v[38:39], v205 offset:9216
  s_waitcnt vmcnt(13)
  s_waitcnt lgkmcnt(4)
  v_mfma_f32_32x32x16_bf16 v[0:15], v[56:59], v[76:79], v[0:15]
  ds_read_b64_tr_b16 v[40:41], v204 offset:10240
  ds_read_b64_tr_b16 v[42:43], v204 offset:11264
  buffer_load_dwordx4 v[132:135], v201, s[12:15], s66 offen sc1
  v_mfma_f32_32x32x16_bf16 v[16:31], v[60:63], v[76:79], v[16:31]
  ds_read_b64_tr_b16 v[44:45], v205 offset:10240
  ds_read_b64_tr_b16 v[46:47], v205 offset:11264
  s_waitcnt vmcnt(13)
  s_waitcnt lgkmcnt(4)
  v_mfma_f32_32x32x16_bf16 v[0:15], v[32:35], v[80:83], v[0:15]
  ds_read_b64_tr_b16 v[48:49], v204 offset:12288
  ds_read_b64_tr_b16 v[50:51], v204 offset:13312
  buffer_load_dwordx4 v[136:139], v202, s[12:15], s66 offen sc1
  v_mfma_f32_32x32x16_bf16 v[16:31], v[36:39], v[80:83], v[16:31]
  ds_read_b64_tr_b16 v[52:53], v205 offset:12288
  ds_read_b64_tr_b16 v[54:55], v205 offset:13312
  s_waitcnt vmcnt(13)
  s_waitcnt lgkmcnt(4)
  v_mfma_f32_32x32x16_bf16 v[0:15], v[40:43], v[84:87], v[0:15]
  ds_read_b64_tr_b16 v[56:57], v204 offset:14336
  ds_read_b64_tr_b16 v[58:59], v204 offset:15360
  buffer_load_dwordx4 v[140:143], v203, s[12:15], s66 offen sc1
  v_mfma_f32_32x32x16_bf16 v[16:31], v[44:47], v[84:87], v[16:31]
  ds_read_b64_tr_b16 v[60:61], v205 offset:14336
  ds_read_b64_tr_b16 v[62:63], v205 offset:15360
  s_waitcnt vmcnt(13)
  s_waitcnt lgkmcnt(4)
  s_cmp_eq_u32 s65, 56
  s_cselect_b32 s56, 0xfffe0000, 0
  v_add_u32 v204, s56, v204
  v_add_u32 v205, s56, v205
  v_mfma_f32_32x32x16_bf16 v[0:15], v[48:51], v[88:91], v[0:15]
  ds_read_b64_tr_b16 v[32:33], v204 offset:16384
  ds_read_b64_tr_b16 v[34:35], v204 offset:17408
  s_add_u32 s66, s65, 20
  s_and_b32 s66, s66, 63
  s_lshl_b32 s66, s66, 12
  s_add_u32 s66, s66, s64
  buffer_load_dwordx4 v[144:147], v200, s[12:15], s66 offen sc1
  v_mfma_f32_32x32x16_bf16 v[16:31], v[52:55], v[88:91], v[16:31]
  ds_read_b64_tr_b16 v[36:37], v205 offset:16384
  ds_read_b64_tr_b16 v[38:39], v205 offset:17408
  s_waitcnt vmcnt(13)
  s_waitcnt lgkmcnt(4)
  v_mfma_f32_32x32x16_bf16 v[0:15], v[56:59], v[92:95], v[0:15]
  ds_read_b64_tr_b16 v[40:41], v204 offset:18432
  ds_read_b64_tr_b16 v[42:43], v204 offset:19456
  buffer_load_dwordx4 v[148:151], v201, s[12:15], s66 offen sc1
  v_mfma_f32_32x32x16_bf16 v[16:31], v[60:63], v[92:95], v[16:31]
  ds_read_b64_tr_b16 v[44:45], v205 offset:18432
  ds_read_b64_tr_b16 v[46:47], v205 offset:19456
  s_waitcnt vmcnt(13)
  s_waitcnt lgkmcnt(4)
  v_mfma_f32_32x32x16_bf16 v[0:15], v[32:35], v[96:99], v[0:15]
  ds_read_b64_tr_b16 v[48:49], v204 offset:20480
  ds_read_b64_tr_b16 v[50:51], v204 offset:21504
  buffer_load_dwordx4 v[152:155], v202, s[12:15], s66 offen sc1
  v_mfma_f32_32x32x16_bf16 v[16:31], v[36:39], v[96:99], v[16:31]
  ds_read_b64_tr_b16 v[52:53], v205 offset:20480
  ds_read_b64_tr_b16 v[54:55], v205 offset:21504
  s_waitcnt vmcnt(13)
  s_waitcnt lgkmcnt(4)
  v_mfma_f32_32x32x16_bf16 v[0:15], v[40:43], v[100:103], v[0:15]
  ds_read_b64_tr_b16 v[56:57], v204 offset:22528
  ds_read_b64_tr_b16 v[58:59], v204 offset:23552
  buffer_load_dwordx4 v[156:159], v203, s[12:15], s66 offen sc1
  v_mfma_f32_32x32x16_bf16 v[16:31], v[44:47], v[100:103], v[16:31]
  ds_read_b64_tr_b16 v[60:61], v205 offset:22528
  ds_read_b64_tr_b16 v[62:63], v205 offset:23552
  s_waitcnt vmcnt(13)
  s_waitcnt lgkmcnt(4)
  s_cmp_eq_u32 s65, 52
  s_cselect_b32 s56, 0xfffe0000, 0
  v_add_u32 v204, s56, v204
  v_add_u32 v205, s56, v205
  v_mfma_f32_32x32x16_bf16 v[0:15], v[48:51], v[104:107], v[0:15]
  ds_read_b64_tr_b16 v[32:33], v204 offset:24576
  ds_read_b64_tr_b16 v[34:35], v204 offset:25600
  s_add_u32 s66, s65, 24
  s_and_b32 s66, s66, 63
  s_lshl_b32 s66, s66, 12
  s_add_u32 s66, s66, s64
  buffer_load_dwordx4 v[160:163], v200, s[12:15], s66 offen sc1
  v_mfma_f32_32x32x16_bf16 v[16:31], v[52:55], v[104:107], v[16:31]
  ds_read_b64_tr_b16 v[36:37], v205 offset:24576
  ds_read_b64_tr_b16 v[38:39], v205 offset:25600
  s_waitcnt vmcnt(13)
  s_waitcnt lgkmcnt(4)
  v_mfma_f32_32x32x16_bf16 v[0:15], v[56:59], v[108:111], v[0:15]
  ds_read_b64_tr_b16 v[40:41], v204 offset:26624
  ds_read_b64_tr_b16 v[42:43], v204 offset:27648
  buffer_load_dwordx4 v[164:167], v201, s[12:15], s66 offen sc1
  v_mfma_f32_32x32x16_bf16 v[16:31], v[60:63], v[108:111], v[16:31]
  ds_read_b64_tr_b16 v[44:45], v205 offset:26624
  ds_read_b64_tr_b16 v[46:47], v205 offset:27648
  s_waitcnt vmcnt(13)
  s_waitcnt lgkmcnt(4)
  v_mfma_f32_32x32x16_bf16 v[0:15], v[32:35], v[112:115], v[0:15]
  ds_read_b64_tr_b16 v[48:49], v204 offset:28672
  ds_read_b64_tr_b16 v[50:51], v204 offset:29696
  buffer_load_dwordx4 v[168:171], v202, s[12:15], s66 offen sc1
  v_mfma_f32_32x32x16_bf16 v[16:31], v[36:39], v[112:115], v[16:31]
  ds_read_b64_tr_b16 v[52:53], v205 offset:28672
  ds_read_b64_tr_b16 v[54:55], v205 offset:29696
  s_waitcnt vmcnt(13)
  s_waitcnt lgkmcnt(4)
  v_mfma_f32_32x32x16_bf16 v[0:15], v[40:43], v[116:119], v[0:15]
  ds_read_b64_tr_b16 v[56:57], v204 offset:30720
  ds_read_b64_tr_b16 v[58:59], v204 offset:31744
  buffer_load_dwordx4 v[172:175], v203, s[12:15], s66 offen sc1
  v_mfma_f32_32x32x16_bf16 v[16:31], v[44:47], v[116:119], v[16:31]
  ds_read_b64_tr_b16 v[60:61], v205 offset:30720
  ds_read_b64_tr_b16 v[62:63], v205 offset:31744
  s_waitcnt vmcnt(13)
  s_waitcnt lgkmcnt(4)
  s_cmp_eq_u32 s65, 48
  s_cselect_b32 s56, 0xfffe0000, 0
  v_add_u32 v204, s56, v204
  v_add_u32 v205, s56, v205
  v_mfma_f32_32x32x16_bf16 v[0:15], v[48:51], v[120:123], v[0:15]
  ds_read_b64_tr_b16 v[32:33], v204 offset:32768
  ds_read_b64_tr_b16 v[34:35], v204 offset:33792
  s_add_u32 s66, s65, 28
  s_and_b32 s66, s66, 63
  s_lshl_b32 s66, s66, 12
  s_add_u32 s66, s66, s64
  buffer_load_dwordx4 v[176:179], v200, s[12:15], s66 offen sc1
  v_mfma_f32_32x32x16_bf16 v[16:31], v[52:55], v[120:123], v[16:31]
  ds_read_b64_tr_b16 v[36:37], v205 offset:32768
  ds_read_b64_tr_b16 v[38:39], v205 offset:33792
  s_waitcnt vmcnt(13)
  s_waitcnt lgkmcnt(4)
  v_mfma_f32_32x32x16_bf16 v[0:15], v[56:59], v[124:127], v[0:15]
  ds_read_b64_tr_b16 v[40:41], v204 offset:34816
  ds_read_b64_tr_b16 v[42:43], v204 offset:35840
  buffer_load_dwordx4 v[180:183], v201, s[12:15], s66 offen sc1
  v_mfma_f32_32x32x16_bf16 v[16:31], v[60:63], v[124:127], v[16:31]
  ds_read_b64_tr_b16 v[44:45], v205 offset:34816
  ds_read_b64_tr_b16 v[46:47], v205 offset:35840
  s_waitcnt vmcnt(13)
  s_waitcnt lgkmcnt(4)
  v_mfma_f32_32x32x16_bf16 v[0:15], v[32:35], v[128:131], v[0:15]
  ds_read_b64_tr_b16 v[48:49], v204 offset:36864
  ds_read_b64_tr_b16 v[50:51], v204 offset:37888
  buffer_load_dwordx4 v[184:187], v202, s[12:15], s66 offen sc1
  v_mfma_f32_32x32x16_bf16 v[16:31], v[36:39], v[128:131], v[16:31]
  ds_read_b64_tr_b16 v[52:53], v205 offset:36864
  ds_read_b64_tr_b16 v[54:55], v205 offset:37888
  s_waitcnt vmcnt(13)
  s_waitcnt lgkmcnt(4)
  v_mfma_f32_32x32x16_bf16 v[0:15], v[40:43], v[132:135], v[0:15]
  ds_read_b64_tr_b16 v[56:57], v204 offset:38912
  ds_read_b64_tr_b16 v[58:59], v204 offset:39936
  buffer_load_dwordx4 v[188:191], v203, s[12:15], s66 offen sc1
  v_mfma_f32_32x32x16_bf16 v[16:31], v[44:47], v[132:135], v[16:31]
  ds_read_b64_tr_b16 v[60:61], v205 offset:38912
  ds_read_b64_tr_b16 v[62:63], v205 offset:39936
  s_waitcnt vmcnt(13)
  s_waitcnt lgkmcnt(4)
  s_cmp_eq_u32 s65, 44
  s_cselect_b32 s56, 0xfffe0000, 0
  v_add_u32 v204, s56, v204
  v_add_u32 v205, s56, v205
  v_mfma_f32_32x32x16_bf16 v[0:15], v[48:51], v[136:139], v[0:15]
  ds_read_b64_tr_b16 v[32:33], v204 offset:40960
  ds_read_b64_tr_b16 v[34:35], v204 offset:41984
  s_add_u32 s66, s65, 32
  s_and_b32 s66, s66, 63
  s_lshl_b32 s66, s66, 12
  s_add_u32 s66, s66, s64
  buffer_load_dwordx4 v[64:67], v200, s[12:15], s66 offen sc1
  v_mfma_f32_32x32x16_bf16 v[16:31], v[52:55], v[136:139], v[16:31]
  ds_read_b64_tr_b16 v[36:37], v205 offset:40960
  ds_read_b64_tr_b16 v[38:39], v205 offset:41984
  s_waitcnt vmcnt(13)
  s_waitcnt lgkmcnt(4)
  v_mfma_f32_32x32x16_bf16 v[0:15], v[56:59], v[140:143], v[0:15]
  ds_read_b64_tr_b16 v[40:41], v204 offset:43008
  ds_read_b64_tr_b16 v[42:43], v204 offset:44032
  buffer_load_dwordx4 v[68:71], v201, s[12:15], s66 offen sc1
  v_mfma_f32_32x32x16_bf16 v[16:31], v[60:63], v[140:143], v[16:31]
  ds_read_b64_tr_b16 v[44:45], v205 offset:43008
  ds_read_b64_tr_b16 v[46:47], v205 offset:44032
  s_waitcnt vmcnt(13)
  s_waitcnt lgkmcnt(4)
  v_mfma_f32_32x32x16_bf16 v[0:15], v[32:35], v[144:147], v[0:15]
  ds_read_b64_tr_b16 v[48:49], v204 offset:45056
  ds_read_b64_tr_b16 v[50:51], v204 offset:46080
  buffer_load_dwordx4 v[72:75], v202, s[12:15], s66 offen sc1
  v_mfma_f32_32x32x16_bf16 v[16:31], v[36:39], v[144:147], v[16:31]
  ds_read_b64_tr_b16 v[52:53], v205 offset:45056
  ds_read_b64_tr_b16 v[54:55], v205 offset:46080
  s_waitcnt vmcnt(13)
  s_waitcnt lgkmcnt(4)
  v_mfma_f32_32x32x16_bf16 v[0:15], v[40:43], v[148:151], v[0:15]
  ds_read_b64_tr_b16 v[56:57], v204 offset:47104
  ds_read_b64_tr_b16 v[58:59], v204 offset:48128
  buffer_load_dwordx4 v[76:79], v203, s[12:15], s66 offen sc1
  v_mfma_f32_32x32x16_bf16 v[16:31], v[44:47], v[148:151], v[16:31]
  ds_read_b64_tr_b16 v[60:61], v205 offset:47104
  ds_read_b64_tr_b16 v[62:63], v205 offset:48128
  s_waitcnt vmcnt(13)
  s_waitcnt lgkmcnt(4)
  s_cmp_eq_u32 s65, 40
  s_cselect_b32 s56, 0xfffe0000, 0
  v_add_u32 v204, s56, v204
  v_add_u32 v205, s56, v205
  v_mfma_f32_32x32x16_bf16 v[0:15], v[48:51], v[152:155], v[0:15]
  ds_read_b64_tr_b16 v[32:33], v204 offset:49152
  ds_read_b64_tr_b16 v[34:35], v204 offset:50176
  s_add_u32 s66, s65, 36
  s_and_b32 s66, s66, 63
  s_lshl_b32 s66, s66, 12
  s_add_u32 s66, s66, s64
  buffer_load_dwordx4 v[80:83], v200, s[12:15], s66 offen sc1
  v_mfma_f32_32x32x16_bf16 v[16:31], v[52:55], v[152:155], v[16:31]
  ds_read_b64_tr_b16 v[36:37], v205 offset:49152
  ds_read_b64_tr_b16 v[38:39], v205 offset:50176
  s_waitcnt vmcnt(13)
  s_waitcnt lgkmcnt(4)
  v_mfma_f32_32x32x16_bf16 v[0:15], v[56:59], v[156:159], v[0:15]
  ds_read_b64_tr_b16 v[40:41], v204 offset:51200
  ds_read_b64_tr_b16 v[42:43], v204 offset:52224
  buffer_load_dwordx4 v[84:87], v201, s[12:15], s66 offen sc1
  v_mfma_f32_32x32x16_bf16 v[16:31], v[60:63], v[156:159], v[16:31]
  ds_read_b64_tr_b16 v[44:45], v205 offset:51200
  ds_read_b64_tr_b16 v[46:47], v205 offset:52224
  s_waitcnt vmcnt(13)
  s_waitcnt lgkmcnt(4)
  v_mfma_f32_32x32x16_bf16 v[0:15], v[32:35], v[160:163], v[0:15]
  ds_read_b64_tr_b16 v[48:49], v204 offset:53248
  ds_read_b64_tr_b16 v[50:51], v204 offset:54272
  buffer_load_dwordx4 v[88:91], v202, s[12:15], s66 offen sc1
  v_mfma_f32_32x32x16_bf16 v[16:31], v[36:39], v[160:163], v[16:31]
  ds_read_b64_tr_b16 v[52:53], v205 offset:53248
  ds_read_b64_tr_b16 v[54:55], v205 offset:54272
  s_waitcnt vmcnt(13)
  s_waitcnt lgkmcnt(4)
  v_mfma_f32_32x32x16_bf16 v[0:15], v[40:43], v[164:167], v[0:15]
  ds_read_b64_tr_b16 v[56:57], v204 offset:55296
  ds_read_b64_tr_b16 v[58:59], v204 offset:56320
  buffer_load_dwordx4 v[92:95], v203, s[12:15], s66 offen sc1
  v_mfma_f32_32x32x16_bf16 v[16:31], v[44:47], v[164:167], v[16:31]
  ds_read_b64_tr_b16 v[60:61], v205 offset:55296
  ds_read_b64_tr_b16 v[62:63], v205 offset:56320
  s_waitcnt vmcnt(13)
  s_waitcnt lgkmcnt(4)
  s_cmp_eq_u32 s65, 36
  s_cselect_b32 s56, 0xfffe0000, 0
  v_add_u32 v204, s56, v204
  v_add_u32 v205, s56, v205
  v_mfma_f32_32x32x16_bf16 v[0:15], v[48:51], v[168:171], v[0:15]
  ds_read_b64_tr_b16 v[32:33], v204 offset:57344
  ds_read_b64_tr_b16 v[34:35], v204 offset:58368
  s_add_u32 s66, s65, 40
  s_and_b32 s66, s66, 63
  s_lshl_b32 s66, s66, 12
  s_add_u32 s66, s66, s64
  buffer_load_dwordx4 v[96:99], v200, s[12:15], s66 offen sc1
  v_mfma_f32_32x32x16_bf16 v[16:31], v[52:55], v[168:171], v[16:31]
  ds_read_b64_tr_b16 v[36:37], v205 offset:57344
  ds_read_b64_tr_b16 v[38:39], v205 offset:58368
  s_waitcnt vmcnt(13)
  s_waitcnt lgkmcnt(4)
  v_mfma_f32_32x32x16_bf16 v[0:15], v[56:59], v[172:175], v[0:15]
  ds_read_b64_tr_b16 v[40:41], v204 offset:59392
  ds_read_b64_tr_b16 v[42:43], v204 offset:60416
  buffer_load_dwordx4 v[100:103], v201, s[12:15], s66 offen sc1
  v_mfma_f32_32x32x16_bf16 v[16:31], v[60:63], v[172:175], v[16:31]
  ds_read_b64_tr_b16 v[44:45], v205 offset:59392
  ds_read_b64_tr_b16 v[46:47], v205 offset:60416
  s_waitcnt vmcnt(13)
  s_waitcnt lgkmcnt(4)
  v_mfma_f32_32x32x16_bf16 v[0:15], v[32:35], v[176:179], v[0:15]
  ds_read_b64_tr_b16 v[48:49], v204 offset:61440
  ds_read_b64_tr_b16 v[50:51], v204 offset:62464
  buffer_load_dwordx4 v[104:107], v202, s[12:15], s66 offen sc1
  v_mfma_f32_32x32x16_bf16 v[16:31], v[36:39], v[176:179], v[16:31]
  ds_read_b64_tr_b16 v[52:53], v205 offset:61440
  ds_read_b64_tr_b16 v[54:55], v205 offset:62464
  s_waitcnt vmcnt(13)
  s_waitcnt lgkmcnt(4)
  v_mfma_f32_32x32x16_bf16 v[0:15], v[40:43], v[180:183], v[0:15]
  ds_read_b64_tr_b16 v[56:57], v204 offset:63488
  ds_read_b64_tr_b16 v[58:59], v204 offset:64512
  buffer_load_dwordx4 v[108:111], v203, s[12:15], s66 offen sc1
  v_mfma_f32_32x32x16_bf16 v[16:31], v[44:47], v[180:183], v[16:31]
  ds_read_b64_tr_b16 v[60:61], v205 offset:63488
  ds_read_b64_tr_b16 v[62:63], v205 offset:64512
  s_waitcnt vmcnt(13)
  s_waitcnt lgkmcnt(4)
  v_and_b32 v210, 3, v250
  v_lshlrev_b32 v210, 2, v210
  v_add_u32 v210, 160592, v210
  s_mov_b32 s63, 160000
wf_8:
  ds_read_b32 v211, v210
  s_waitcnt lgkmcnt(0)
  v_cmp_ne_u32 vcc, s51, v211
  s_cbranch_vccz wfd_9
  s_sub_u32 s63, s63, 1
  s_cbranch_scc0 wf_8
wfd_9:
  s_cmp_eq_u32 s65, 32
  s_cselect_b32 s56, 0xfffe0000, 0
  s_add_u32 s56, s56, 0x10000
  v_add_u32 v204, s56, v204
  v_add_u32 v205, s56, v205
  v_mfma_f32_32x32x16_bf16 v[0:15], v[48:51], v[184:187], v[0:15]
  ds_read_b64_tr_b16 v[32:33], v204 offset:0
  ds_read_b64_tr_b16 v[34:35], v204 offset:1024
  s_add_u32 s66, s65, 44
  s_and_b32 s66, s66, 63
  s_lshl_b32 s66, s66, 12
  s_add_u32 s66, s66, s64
  buffer_load_dwordx4 v[112:115], v200, s[12:15], s66 offen sc1
  v_mfma_f32_32x32x16_bf16 v[16:31], v[52:55], v[184:187], v[16:31]
  ds_read_b64_tr_b16 v[36:37], v205 offset:0
  ds_read_b64_tr_b16 v[38:39], v205 offset:1024
  s_waitcnt vmcnt(13)
  s_waitcnt lgkmcnt(4)
  v_mfma_f32_32x32x16_bf16 v[0:15], v[56:59], v[188:191], v[0:15]
  ds_read_b64_tr_b16 v[40:41], v204 offset:2048
  ds_read_b64_tr_b16 v[42:43], v204 offset:3072
  buffer_load_dwordx4 v[116:119], v201, s[12:15], s66 offen sc1
  v_mfma_f32_32x32x16_bf16 v[16:31], v[60:63], v[188:191], v[16:31]
  ds_read_b64_tr_b16 v[44:45], v205 offset:2048
  ds_read_b64_tr_b16 v[46:47], v205 offset:3072
  s_waitcnt vmcnt(13)
  s_waitcnt lgkmcnt(4)
  v_mfma_f32_32x32x16_bf16 v[0:15], v[32:35], v[64:67], v[0:15]
  ds_read_b64_tr_b16 v[48:49], v204 offset:4096
  ds_read_b64_tr_b16 v[50:51], v204 offset:5120
  buffer_load_dwordx4 v[120:123], v202, s[12:15], s66 offen sc1
  v_mfma_f32_32x32x16_bf16 v[16:31], v[36:39], v[64:67], v[16:31]
  ds_read_b64_tr_b16 v[52:53], v205 offset:4096
  ds_read_b64_tr_b16 v[54:55], v205 offset:5120
  s_waitcnt vmcnt(13)
  s_waitcnt lgkmcnt(4)
  v_mfma_f32_32x32x16_bf16 v[0:15], v[40:43], v[68:71], v[0:15]
  ds_read_b64_tr_b16 v[56:57], v204 offset:6144
  ds_read_b64_tr_b16 v[58:59], v204 offset:7168
  buffer_load_dwordx4 v[124:127], v203, s[12:15], s66 offen sc1
  v_mfma_f32_32x32x16_bf16 v[16:31], v[44:47], v[68:71], v[16:31]
  ds_read_b64_tr_b16 v[60:61], v205 offset:6144
  ds_read_b64_tr_b16 v[62:63], v205 offset:7168
  s_waitcnt vmcnt(13)
  s_waitcnt lgkmcnt(4)
  s_cmp_eq_u32 s65, 28
  s_cselect_b32 s56, 0xfffe0000, 0
  v_add_u32 v204, s56, v204
  v_add_u32 v205, s56, v205
  v_mfma_f32_32x32x16_bf16 v[0:15], v[48:51], v[72:75], v[0:15]
  ds_read_b64_tr_b16 v[32:33], v204 offset:8192
  ds_read_b64_tr_b16 v[34:35], v204 offset:9216
  s_add_u32 s66, s65, 48
  s_and_b32 s66, s66, 63
  s_lshl_b32 s66, s66, 12
  s_add_u32 s66, s66, s64
  buffer_load_dwordx4 v[128:131], v200, s[12:15], s66 offen sc1
  v_mfma_f32_32x32x16_bf16 v[16:31], v[52:55], v[72:75], v[16:31]
  ds_read_b64_tr_b16 v[36:37], v205 offset:8192
  ds_read_b64_tr_b16 v[38:39], v205 offset:9216
  s_waitcnt vmcnt(13)
  s_waitcnt lgkmcnt(4)
  v_mfma_f32_32x32x16_bf16 v[0:15], v[56:59], v[76:79], v[0:15]
  ds_read_b64_tr_b16 v[40:41], v204 offset:10240
  ds_read_b64_tr_b16 v[42:43], v204 offset:11264
  buffer_load_dwordx4 v[132:135], v201, s[12:15], s66 offen sc1
  v_mfma_f32_32x32x16_bf16 v[16:31], v[60:63], v[76:79], v[16:31]
  ds_read_b64_tr_b16 v[44:45], v205 offset:10240
  ds_read_b64_tr_b16 v[46:47], v205 offset:11264
  s_waitcnt vmcnt(13)
  s_waitcnt lgkmcnt(4)
  v_mfma_f32_32x32x16_bf16 v[0:15], v[32:35], v[80:83], v[0:15]
  ds_read_b64_tr_b16 v[48:49], v204 offset:12288
  ds_read_b64_tr_b16 v[50:51], v204 offset:13312
  buffer_load_dwordx4 v[136:139], v202, s[12:15], s66 offen sc1
  v_mfma_f32_32x32x16_bf16 v[16:31], v[36:39], v[80:83], v[16:31]
  ds_read_b64_tr_b16 v[52:53], v205 offset:12288
  ds_read_b64_tr_b16 v[54:55], v205 offset:13312
  s_waitcnt vmcnt(13)
  s_waitcnt lgkmcnt(4)
  v_mfma_f32_32x32x16_bf16 v[0:15], v[40:43], v[84:87], v[0:15]
  ds_read_b64_tr_b16 v[56:57], v204 offset:14336
  ds_read_b64_tr_b16 v[58:59], v204 offset:15360
  buffer_load_dwordx4 v[140:143], v203, s[12:15], s66 offen sc1
  v_mfma_f32_32x32x16_bf16 v[16:31], v[44:47], v[84:87], v[16:31]
  ds_read_b64_tr_b16 v[60:61], v205 offset:14336
  ds_read_b64_tr_b16 v[62:63], v205 offset:15360
  s_waitcnt vmcnt(13)
  s_waitcnt lgkmcnt(4)
  s_cmp_eq_u32 s65, 24
  s_cselect_b32 s56, 0xfffe0000, 0
  v_add_u32 v204, s56, v204
  v_add_u32 v205, s56, v205
  v_mfma_f32_32x32x16_bf16 v[0:15], v[48:51], v[88:91], v[0:15]
  ds_read_b64_tr_b16 v[32:33], v204 offset:16384
  ds_read_b64_tr_b16 v[34:35], v204 offset:17408
  s_add_u32 s66, s65, 52
  s_and_b32 s66, s66, 63
  s_lshl_b32 s66, s66, 12
  s_add_u32 s66, s66, s64
  buffer_load_dwordx4 v[144:147], v200, s[12:15], s66 offen sc1
  v_mfma_f32_32x32x16_bf16 v[16:31], v[52:55], v[88:91], v[16:31]
  ds_read_b64_tr_b16 v[36:37], v205 offset:16384
  ds_read_b64_tr_b16 v[38:39], v205 offset:17408
  s_waitcnt vmcnt(13)
  s_waitcnt lgkmcnt(4)
  v_mfma_f32_32x32x16_bf16 v[0:15], v[56:59], v[92:95], v[0:15]
  ds_read_b64_tr_b16 v[40:41], v204 offset:18432
  ds_read_b64_tr_b16 v[42:43], v204 offset:19456
  buffer_load_dwordx4 v[148:151], v201, s[12:15], s66 offen sc1
  v_mfma_f32_32x32x16_bf16 v[16:31], v[60:63], v[92:95], v[16:31]
  ds_read_b64_tr_b16 v[44:45], v205 offset:18432
  ds_read_b64_tr_b16 v[46:47], v205 offset:19456
  s_waitcnt vmcnt(13)
  s_waitcnt lgkmcnt(4)
  v_mfma_f32_32x32x16_bf16 v[0:15], v[32:35], v[96:99], v[0:15]
  ds_read_b64_tr_b16 v[48:49], v204 offset:20480
  ds_read_b64_tr_b16 v[50:51], v204 offset:21504
  buffer_load_dwordx4 v[152:155], v202, s[12:15], s66 offen sc1
  v_mfma_f32_32x32x16_bf16 v[16:31], v[36:39], v[96:99], v[16:31]
  ds_read_b64_tr_b16 v[52:53], v205 offset:20480
  ds_read_b64_tr_b16 v[54:55], v205 offset:21504
  s_waitcnt vmcnt(13)
  s_waitcnt lgkmcnt(4)
  v_mfma_f32_32x32x16_bf16 v[0:15], v[40:43], v[100:103], v[0:15]
  ds_read_b64_tr_b16 v[56:57], v204 offset:22528
  ds_read_b64_tr_b16 v[58:59], v204 offset:23552
  buffer_load_dwordx4 v[156:159], v203, s[12:15], s66 offen sc1
  v_mfma_f32_32x32x16_bf16 v[16:31], v[44:47], v[100:103], v[16:31]
  ds_read_b64_tr_b16 v[60:61], v205 offset:22528
  ds_read_b64_tr_b16 v[62:63], v205 offset:23552
  s_waitcnt vmcnt(13)
  s_waitcnt lgkmcnt(4)
  s_cmp_eq_u32 s65, 20
  s_cselect_b32 s56, 0xfffe0000, 0
  v_add_u32 v204, s56, v204
  v_add_u32 v205, s56, v205
  v_mfma_f32_32x32x16_bf16 v[0:15], v[48:51], v[104:107], v[0:15]
  ds_read_b64_tr_b16 v[32:33], v204 offset:24576
  ds_read_b64_tr_b16 v[34:35], v204 offset:25600
  s_add_u32 s66, s65, 56
  s_and_b32 s66, s66, 63
  s_lshl_b32 s66, s66, 12
  s_add_u32 s66, s66, s64
  buffer_load_dwordx4 v[160:163], v200, s[12:15], s66 offen sc1
  v_mfma_f32_32x32x16_bf16 v[16:31], v[52:55], v[104:107], v[16:31]
  ds_read_b64_tr_b16 v[36:37], v205 offset:24576
  ds_read_b64_tr_b16 v[38:39], v205 offset:25600
  s_waitcnt vmcnt(13)
  s_waitcnt lgkmcnt(4)
  v_mfma_f32_32x32x16_bf16 v[0:15], v[56:59], v[108:111], v[0:15]
  ds_read_b64_tr_b16 v[40:41], v204 offset:26624
  ds_read_b64_tr_b16 v[42:43], v204 offset:27648
  buffer_load_dwordx4 v[164:167], v201, s[12:15], s66 offen sc1
  v_mfma_f32_32x32x16_bf16 v[16:31], v[60:63], v[108:111], v[16:31]
  ds_read_b64_tr_b16 v[44:45], v205 offset:26624
  ds_read_b64_tr_b16 v[46:47], v205 offset:27648
  s_waitcnt vmcnt(13)
  s_waitcnt lgkmcnt(4)
  v_mfma_f32_32x32x16_bf16 v[0:15], v[32:35], v[112:115], v[0:15]
  ds_read_b64_tr_b16 v[48:49], v204 offset:28672
  ds_read_b64_tr_b16 v[50:51], v204 offset:29696
  buffer_load_dwordx4 v[168:171], v202, s[12:15], s66 offen sc1
  v_mfma_f32_32x32x16_bf16 v[16:31], v[36:39], v[112:115], v[16:31]
  ds_read_b64_tr_b16 v[52:53], v205 offset:28672
  ds_read_b64_tr_b16 v[54:55], v205 offset:29696
  s_waitcnt vmcnt(13)
  s_waitcnt lgkmcnt(4)
  v_mfma_f32_32x32x16_bf16 v[0:15], v[40:43], v[116:119], v[0:15]
  ds_read_b64_tr_b16 v[56:57], v204 offset:30720
  ds_read_b64_tr_b16 v[58:59], v204 offset:31744
  buffer_load_dwordx4 v[172:175], v203, s[12:15], s66 offen sc1
  v_mfma_f32_32x32x16_bf16 v[16:31], v[44:47], v[116:119], v[16:31]
  ds_read_b64_tr_b16 v[60:61], v205 offset:30720
  ds_read_b64_tr_b16 v[62:63], v205 offset:31744
  s_waitcnt vmcnt(13)
  s_waitcnt lgkmcnt(4)
  s_cmp_eq_u32 s65, 16
  s_cselect_b32 s56, 0xfffe0000, 0
  v_add_u32 v204, s56, v204
  v_add_u32 v205, s56, v205
  v_mfma_f32_32x32x16_bf16 v[0:15], v[48:51], v[120:123], v[0:15]
  ds_read_b64_tr_b16 v[32:33], v204 offset:32768
  ds_read_b64_tr_b16 v[34:35], v204 offset:33792
  s_add_u32 s66, s65, 60
  s_and_b32 s66, s66, 63
  s_lshl_b32 s66, s66, 12
  s_add_u32 s66, s66, s64
  buffer_load_dwordx4 v[176:179], v200, s[12:15], s66 offen sc1
  v_mfma_f32_32x32x16_bf16 v[16:31], v[52:55], v[120:123], v[16:31]
  ds_read_b64_tr_b16 v[36:37], v205 offset:32768
  ds_read_b64_tr_b16 v[38:39], v205 offset:33792
  s_waitcnt vmcnt(13)
  s_waitcnt lgkmcnt(4)
  v_mfma_f32_32x32x16_bf16 v[0:15], v[56:59], v[124:127], v[0:15]
  ds_read_b64_tr_b16 v[40:41], v204 offset:34816
  ds_read_b64_tr_b16 v[42:43], v204 offset:35840
  buffer_load_dwordx4 v[180:183], v201, s[12:15], s66 offen sc1
  v_mfma_f32_32x32x16_bf16 v[16:31], v[60:63], v[124:127], v[16:31]
  ds_read_b64_tr_b16 v[44:45], v205 offset:34816
  ds_read_b64_tr_b16 v[46:47], v205 offset:35840
  s_waitcnt vmcnt(13)
  s_waitcnt lgkmcnt(4)
  v_mfma_f32_32x32x16_bf16 v[0:15], v[32:35], v[128:131], v[0:15]
  ds_read_b64_tr_b16 v[48:49], v204 offset:36864
  ds_read_b64_tr_b16 v[50:51], v204 offset:37888
  buffer_load_dwordx4 v[184:187], v202, s[12:15], s66 offen sc1
  v_mfma_f32_32x32x16_bf16 v[16:31], v[36:39], v[128:131], v[16:31]
  ds_read_b64_tr_b16 v[52:53], v205 offset:36864
  ds_read_b64_tr_b16 v[54:55], v205 offset:37888
  s_waitcnt vmcnt(13)
  s_waitcnt lgkmcnt(4)
  v_mfma_f32_32x32x16_bf16 v[0:15], v[40:43], v[132:135], v[0:15]
  ds_read_b64_tr_b16 v[56:57], v204 offset:38912
  ds_read_b64_tr_b16 v[58:59], v204 offset:39936
  buffer_load_dwordx4 v[188:191], v203, s[12:15], s66 offen sc1
  v_mfma_f32_32x32x16_bf16 v[16:31], v[44:47], v[132:135], v[16:31]
  ds_read_b64_tr_b16 v[60:61], v205 offset:38912
  ds_read_b64_tr_b16 v[62:63], v205 offset:39936
  s_waitcnt vmcnt(13)
  s_waitcnt lgkmcnt(4)
  s_cmp_eq_u32 s65, 12
  s_cselect_b32 s56, 0xfffe0000, 0
  v_add_u32 v204, s56, v204
  v_add_u32 v205, s56, v205
  v_mfma_f32_32x32x16_bf16 v[0:15], v[48:51], v[136:139], v[0:15]
  ds_read_b64_tr_b16 v[32:33], v204 offset:40960
  ds_read_b64_tr_b16 v[34:35], v204 offset:41984
  v_mfma_f32_32x32x16_bf16 v[16:31], v[52:55], v[136:139], v[16:31]
  ds_read_b64_tr_b16 v[36:37], v205 offset:40960
  ds_read_b64_tr_b16 v[38:39], v205 offset:41984
  s_waitcnt vmcnt(12)
  s_waitcnt lgkmcnt(4)
  v_mfma_f32_32x32x16_bf16 v[0:15], v[56:59], v[140:143], v[0:15]
  ds_read_b64_tr_b16 v[40:41], v204 offset:43008
  ds_read_b64_tr_b16 v[42:43], v204 offset:44032
  v_mfma_f32_32x32x16_bf16 v[16:31], v[60:63], v[140:143], v[16:31]
  ds_read_b64_tr_b16 v[44:45], v205 offset:43008
  ds_read_b64_tr_b16 v[46:47], v205 offset:44032
  s_waitcnt vmcnt(11)
  s_waitcnt lgkmcnt(4)
  v_mfma_f32_32x32x16_bf16 v[0:15], v[32:35], v[144:147], v[0:15]
  ds_read_b64_tr_b16 v[48:49], v204 offset:45056
  ds_read_b64_tr_b16 v[50:51], v204 offset:46080
  v_mfma_f32_32x32x16_bf16 v[16:31], v[36:39], v[144:147], v[16:31]
  ds_read_b64_tr_b16 v[52:53], v205 offset:45056
  ds_read_b64_tr_b16 v[54:55], v205 offset:46080
  s_waitcnt vmcnt(10)
  s_waitcnt lgkmcnt(4)
  v_mfma_f32_32x32x16_bf16 v[0:15], v[40:43], v[148:151], v[0:15]
  ds_read_b64_tr_b16 v[56:57], v204 offset:47104
  ds_read_b64_tr_b16 v[58:59], v204 offset:48128
  v_mfma_f32_32x32x16_bf16 v[16:31], v[44:47], v[148:151], v[16:31]
  ds_read_b64_tr_b16 v[60:61], v205 offset:47104
  ds_read_b64_tr_b16 v[62:63], v205 offset:48128
  s_waitcnt vmcnt(9)
  s_waitcnt lgkmcnt(4)
  s_cmp_eq_u32 s65, 8
  s_cselect_b32 s56, 0xfffe0000, 0
  v_add_u32 v204, s56, v204
  v_add_u32 v205, s56, v205
  v_mfma_f32_32x32x16_bf16 v[0:15], v[48:51], v[152:155], v[0:15]
  ds_read_b64_tr_b16 v[32:33], v204 offset:49152
  ds_read_b64_tr_b16 v[34:35], v204 offset:50176
  v_mfma_f32_32x32x16_bf16 v[16:31], v[52:55], v[152:155], v[16:31]
  ds_read_b64_tr_b16 v[36:37], v205 offset:49152
  ds_read_b64_tr_b16 v[38:39], v205 offset:50176
  s_waitcnt vmcnt(8)
  s_waitcnt lgkmcnt(4)
  v_mfma_f32_32x32x16_bf16 v[0:15], v[56:59], v[156:159], v[0:15]
  ds_read_b64_tr_b16 v[40:41], v204 offset:51200
  ds_read_b64_tr_b16 v[42:43], v204 offset:52224
  v_mfma_f32_32x32x16_bf16 v[16:31], v[60:63], v[156:159], v[16:31]
  ds_read_b64_tr_b16 v[44:45], v205 offset:51200
  ds_read_b64_tr_b16 v[46:47], v205 offset:52224
  s_waitcnt vmcnt(7)
  s_waitcnt lgkmcnt(4)
  v_mfma_f32_32x32x16_bf16 v[0:15], v[32:35], v[160:163], v[0:15]
  ds_read_b64_tr_b16 v[48:49], v204 offset:53248
  ds_read_b64_tr_b16 v[50:51], v204 offset:54272
  v_mfma_f32_32x32x16_bf16 v[16:31], v[36:39], v[160:163], v[16:31]
  ds_read_b64_tr_b16 v[52:53], v205 offset:53248
  ds_read_b64_tr_b16 v[54:55], v205 offset:54272
  s_waitcnt vmcnt(6)
  s_waitcnt lgkmcnt(4)
  v_mfma_f32_32x32x16_bf16 v[0:15], v[40:43], v[164:167], v[0:15]
  ds_read_b64_tr_b16 v[56:57], v204 offset:55296
  ds_read_b64_tr_b16 v[58:59], v204 offset:56320
  v_mfma_f32_32x32x16_bf16 v[16:31], v[44:47], v[164:167], v[16:31]
  ds_read_b64_tr_b16 v[60:61], v205 offset:55296
  ds_read_b64_tr_b16 v[62:63], v205 offset:56320
  s_waitcnt vmcnt(5)
  s_waitcnt lgkmcnt(4)
  s_cmp_eq_u32 s65, 4
  s_cselect_b32 s56, 0xfffe0000, 0
  v_add_u32 v204, s56, v204
  v_add_u32 v205, s56, v205
  v_mfma_f32_32x32x16_bf16 v[0:15], v[48:51], v[168:171], v[0:15]
  ds_read_b64_tr_b16 v[32:33], v204 offset:57344
  ds_read_b64_tr_b16 v[34:35], v204 offset:58368
  v_mfma_f32_32x32x16_bf16 v[16:31], v[52:55], v[168:171], v[16:31]
  ds_read_b64_tr_b16 v[36:37], v205 offset:57344
  ds_read_b64_tr_b16 v[38:39], v205 offset:58368
  s_waitcnt vmcnt(4)
  s_waitcnt lgkmcnt(4)
  v_mfma_f32_32x32x16_bf16 v[0:15], v[56:59], v[172:175], v[0:15]
  ds_read_b64_tr_b16 v[40:41], v204 offset:59392
  ds_read_b64_tr_b16 v[42:43], v204 offset:60416
  v_mfma_f32_32x32x16_bf16 v[16:31], v[60:63], v[172:175], v[16:31]
  ds_read_b64_tr_b16 v[44:45], v205 offset:59392
  ds_read_b64_tr_b16 v[46:47], v205 offset:60416
  s_waitcnt vmcnt(3)
  s_waitcnt lgkmcnt(4)
  v_mfma_f32_32x32x16_bf16 v[0:15], v[32:35], v[176:179], v[0:15]
  ds_read_b64_tr_b16 v[48:49], v204 offset:61440
  ds_read_b64_tr_b16 v[50:51], v204 offset:62464
  v_mfma_f32_32x32x16_bf16 v[16:31], v[36:39], v[176:179], v[16:31]
  ds_read_b64_tr_b16 v[52:53], v205 offset:61440
  ds_read_b64_tr_b16 v[54:55], v205 offset:62464
  s_waitcnt vmcnt(2)
  s_waitcnt lgkmcnt(4)
  v_mfma_f32_32x32x16_bf16 v[0:15], v[40:43], v[180:183], v[0:15]
  ds_read_b64_tr_b16 v[56:57], v204 offset:63488
  ds_read_b64_tr_b16 v[58:59], v204 offset:64512
  v_mfma_f32_32x32x16_bf16 v[16:31], v[44:47], v[180:183], v[16:31]
  ds_read_b64_tr_b16 v[60:61], v205 offset:63488
  ds_read_b64_tr_b16 v[62:63], v205 offset:64512
  s_waitcnt vmcnt(1)
  s_waitcnt lgkmcnt(4)
  v_mfma_f32_32x32x16_bf16 v[0:15], v[48:51], v[184:187], v[0:15]
  v_mfma_f32_32x32x16_bf16 v[16:31], v[52:55], v[184:187], v[16:31]
  s_waitcnt vmcnt(0)
  s_waitcnt lgkmcnt(0)
  v_mfma_f32_32x32x16_bf16 v[0:15], v[56:59], v[188:191], v[0:15]
  v_mfma_f32_32x32x16_bf16 v[16:31], v[60:63], v[188:191], v[16:31]
  s_waitcnt vmcnt(0) lgkmcnt(0)
  s_nop 7
  s_nop 3
  v_cvt_pk_bf16_f32 v32, v0, v1
  v_cvt_pk_bf16_f32 v33, v2, v3
  v_cvt_pk_bf16_f32 v34, v4, v5
  v_cvt_pk_bf16_f32 v35, v6, v7
  v_cvt_pk_bf16_f32 v36, v8, v9
  v_cvt_pk_bf16_f32 v37, v10, v11
  v_cvt_pk_bf16_f32 v38, v12, v13
  v_cvt_pk_bf16_f32 v39, v14, v15
  v_cvt_pk_bf16_f32 v40, v16, v17
  v_cvt_pk_bf16_f32 v41, v18, v19
  v_cvt_pk_bf16_f32 v42, v20, v21
  v_cvt_pk_bf16_f32 v43, v22, v23
  v_cvt_pk_bf16_f32 v44, v24, v25
  v_cvt_pk_bf16_f32 v45, v26, v27
  v_cvt_pk_bf16_f32 v46, v28, v29
  v_cvt_pk_bf16_f32 v47, v30, v31
  s_nop 1
  v_permlane32_swap_b32 v32, v34
  v_permlane32_swap_b32 v33, v35
  v_permlane32_swap_b32 v36, v38
  v_permlane32_swap_b32 v37, v39
  v_permlane32_swap_b32 v40, v42
  v_permlane32_swap_b32 v41, v43
  v_permlane32_swap_b32 v44, v46
  v_permlane32_swap_b32 v45, v47
  v_and_b32 v208, 31, v250
  v_mul_u32_u24 v208, 144, v208
  v_lshrrev_b32 v209, 5, v250
  v_lshl_add_u32 v208, v209, 4, v208
  s_mul_i32 s56, s50, 4608
  s_add_u32 s56, s56, 131072
  v_add_u32 v208, s56, v208
  v_lshrrev_b32 v209, 3, v250
  v_and_b32 v210, 7, v250
  v_mul_u32_u24 v211, 144, v209
  v_lshl_add_u32 v211, v210, 4, v211
  v_add_u32 v211, s56, v211
  ds_write_b128 v208, v[32:35] offset:0
  ds_write_b128 v208, v[36:39] offset:32
  ds_write_b128 v208, v[40:43] offset:64
  ds_write_b128 v208, v[44:47] offset:96
  s_lshl_b32 s56, s54, 7
  s_lshl_b32 s57, s50, 5
  s_add_u32 s56, s56, s57
  v_add_u32 v212, s56, v209
  v_lshlrev_b32 v212, 12, v212
  v_lshl_add_u32 v212, v210, 4, v212
  s_lshl_b32 s56, s55, 7
  s_add_u32 s56, s56, 2048
  s_waitcnt lgkmcnt(0)
  ds_read_b128 v[48:51], v211 offset:0
  ds_read_b128 v[52:55], v211 offset:1152
  ds_read_b128 v[56:59], v211 offset:2304
  ds_read_b128 v[60:63], v211 offset:3456
  s_waitcnt lgkmcnt(3)
  buffer_store_dwordx4 v[48:51], v212, s[40:43], s56 offen nt
  s_add_u32 s56, s56, 32768
  s_waitcnt lgkmcnt(2)
  buffer_store_dwordx4 v[52:55], v212, s[40:43], s56 offen nt
  s_add_u32 s56, s56, 32768
  s_waitcnt lgkmcnt(1)
  buffer_store_dwordx4 v[56:59], v212, s[40:43], s56 offen nt
  s_add_u32 s56, s56, 32768
  s_waitcnt lgkmcnt(0)
  buffer_store_dwordx4 v[60:63], v212, s[40:43], s56 offen nt
  s_or_b32 s56, s2, s50
  s_cmp_lg_u32 s56, 0
  s_cbranch_scc1 L_noep
  s_mov_b32 s56, 0
  v_mov_b32 v210, 0
  v_mov_b32 v211, s51
  s_mov_b64 exec, 1
  buffer_store_dword v211, v210, s[12:15], s56 offen sc1
  s_mov_b64 exec, -1
L_noep:
  s_waitcnt vmcnt(0)
  s_endpgm
L_helper:
  s_setprio 3
  s_sub_u32 s69, s50, 4
  s_lshr_b32 s52, s69, 1
  s_and_b32 s53, s69, 1
  v_and_b32 v2, 31, v250
  v_lshlrev_b32 v2, 2, v2
  s_lshl_b32 s57, s49, 7
  s_add_u32 s57, s57, 8192
  v_lshlrev_b32 v4, 4, v250
  v_and_b32 v5, 15, v250
  v_lshlrev_b32 v5, 2, v5
  v_lshrrev_b32 v6, 4, v250
  v_mul_u32_u24 v6, 4352, v6
  v_add_u32 v5, v5, v6
  s_lshl_b32 s58, s49, 4
  s_mul_i32 s58, s58, 4352
  s_add_u32 s58, s58, 12648448
  s_lshl_b32 s59, s69, 10
  s_add_u32 s59, s59, s58
  s_lshl_b32 s60, s69, 6
  s_add_u32 s60, s60, s58
  s_add_u32 s60, s60, 4096
  s_mov_b32 s63, 20000
pf2_10:
  buffer_load_dword v3, v2, s[12:15], s57 offen sc1
  s_waitcnt vmcnt(0)
  v_cmp_ne_u32 vcc, s51, v3
  s_cbranch_vccz pf2d_11
  s_sub_u32 s63, s63, 1
  s_cbranch_scc1 pf2d_11
  s_sleep 1
  s_branch pf2_10
pf2d_11:
  s_and_b32 s64, s48, 7
  s_lshl_b32 s64, s64, 1
  s_mul_i32 s65, s64, 4352
  s_add_u32 s56, s59, s65
  buffer_load_dwordx4 v[32:35], v4, s[12:15], s56 offen sc1
  s_add_u32 s57, s60, 0
  buffer_load_dword v160, v5, s[12:15], s57 offen sc1
  s_add_u32 s57, s60, 17408
  buffer_load_dword v161, v5, s[12:15], s57 offen sc1
  s_add_u32 s57, s60, 34816
  buffer_load_dword v162, v5, s[12:15], s57 offen sc1
  s_add_u32 s57, s60, 52224
  buffer_load_dword v163, v5, s[12:15], s57 offen sc1
  s_add_u32 s64, s64, 1
  s_and_b32 s64, s64, 15
  s_mul_i32 s65, s64, 4352
  s_add_u32 s56, s59, s65
  buffer_load_dwordx4 v[36:39], v4, s[12:15], s56 offen sc1
  s_add_u32 s64, s64, 1
  s_and_b32 s64, s64, 15
  s_mul_i32 s65, s64, 4352
  s_add_u32 s56, s59, s65
  buffer_load_dwordx4 v[40:43], v4, s[12:15], s56 offen sc1
  s_add_u32 s64, s64, 1
  s_and_b32 s64, s64, 15
  s_mul_i32 s65, s64, 4352
  s_add_u32 s56, s59, s65
  buffer_load_dwordx4 v[44:47], v4, s[12:15], s56 offen sc1
  s_add_u32 s64, s64, 1
  s_and_b32 s64, s64, 15
  s_mul_i32 s65, s64, 4352
  s_add_u32 s56, s59, s65
  buffer_load_dwordx4 v[48:51], v4, s[12:15], s56 offen sc1
  s_add_u32 s64, s64, 1
  s_and_b32 s64, s64, 15
  s_mul_i32 s65, s64, 4352
  s_add_u32 s56, s59, s65
  buffer_load_dwordx4 v[52:55], v4, s[12:15], s56 offen sc1
  s_add_u32 s64, s64, 1
  s_and_b32 s64, s64, 15
  s_mul_i32 s65, s64, 4352
  s_add_u32 s56, s59, s65
  buffer_load_dwordx4 v[56:59], v4, s[12:15], s56 offen sc1
  s_add_u32 s64, s64, 1
  s_and_b32 s64, s64, 15
  s_mul_i32 s65, s64, 4352
  s_add_u32 s56, s59, s65
  buffer_load_dwordx4 v[60:63], v4, s[12:15], s56 offen sc1
  s_add_u32 s64, s64, 1
  s_and_b32 s64, s64, 15
  s_mul_i32 s65, s64, 4352
  s_add_u32 s56, s59, s65
  buffer_load_dwordx4 v[64:67], v4, s[12:15], s56 offen sc1
  s_add_u32 s64, s64, 1
  s_and_b32 s64, s64, 15
  s_mul_i32 s65, s64, 4352
  s_add_u32 s56, s59, s65
  buffer_load_dwordx4 v[68:71], v4, s[12:15], s56 offen sc1
  s_add_u32 s64, s64, 1
  s_and_b32 s64, s64, 15
  s_mul_i32 s65, s64, 4352
  s_add_u32 s56, s59, s65
  buffer_load_dwordx4 v[72:75], v4, s[12:15], s56 offen sc1
  s_add_u32 s64, s64, 1
  s_and_b32 s64, s64, 15
  s_mul_i32 s65, s64, 4352
  s_add_u32 s56, s59, s65
  buffer_load_dwordx4 v[76:79], v4, s[12:15], s56 offen sc1
  s_add_u32 s64, s64, 1
  s_and_b32 s64, s64, 15
  s_mul_i32 s65, s64, 4352
  s_add_u32 s56, s59, s65
  buffer_load_dwordx4 v[80:83], v4, s[12:15], s56 offen sc1
  s_add_u32 s64, s64, 1
  s_and_b32 s64, s64, 15
  s_mul_i32 s65, s64, 4352
  s_add_u32 s56, s59, s65
  buffer_load_dwordx4 v[84:87], v4, s[12:15], s56 offen sc1
  s_add_u32 s64, s64, 1
  s_and_b32 s64, s64, 15
  s_mul_i32 s65, s64, 4352
  s_add_u32 s56, s59, s65
  buffer_load_dwordx4 v[88:91], v4, s[12:15], s56 offen sc1
  s_add_u32 s64, s64, 1
  s_and_b32 s64, s64, 15
  s_mul_i32 s65, s64, 4352
  s_add_u32 s56, s59, s65
  buffer_load_dwordx4 v[92:95], v4, s[12:15], s56 offen sc1
  s_lshl_b32 s61, s69, 14
  s_lshl_b32 s60, s69, 18
  s_lshl_b32 s56, s69, 12
  s_add_u32 s56, s56, 92160
  v_add_u32 v7, s56, v4
  ds_read_b128 v[200:203], v7 offset:0
  ds_read_b128 v[204:207], v7 offset:1024
  ds_read_b128 v[208:211], v7 offset:2048
  ds_read_b128 v[212:215], v7 offset:3072
  s_waitcnt lgkmcnt(0)
  s_lshl_b32 s62, s69, 2
  s_add_u32 s62, s62, 160560
  v_mov_b32 v8, s62
  v_mov_b32 v9, s51
  ds_write_b32 v8, v9
  s_waitcnt vmcnt(19)
  v_lshlrev_b32 v96, 16, v32
  v_and_b32 v97, 0xffff0000, v32
  v_lshlrev_b32 v98, 16, v33
  v_and_b32 v99, 0xffff0000, v33
  v_lshlrev_b32 v100, 16, v34
  v_and_b32 v101, 0xffff0000, v34
  v_lshlrev_b32 v102, 16, v35
  v_and_b32 v103, 0xffff0000, v35
  s_add_u32 m0, s61, 0
  s_add_u32 s57, s60, 0
  buffer_load_dwordx4 v244, s[36:39], s57 offen offset:0 lds
  buffer_load_dwordx4 v245, s[36:39], s57 offen offset:1024 lds
  buffer_load_dwordx4 v246, s[36:39], s57 offen offset:2048 lds
  buffer_load_dwordx4 v247, s[36:39], s57 offen offset:3072 lds
  s_waitcnt vmcnt(18)
  v_lshlrev_b32 v104, 16, v36
  v_and_b32 v105, 0xffff0000, v36
  v_lshlrev_b32 v106, 16, v37
  v_and_b32 v107, 0xffff0000, v37
  v_lshlrev_b32 v108, 16, v38
  v_and_b32 v109, 0xffff0000, v38
  v_lshlrev_b32 v110, 16, v39
  v_and_b32 v111, 0xffff0000, v39
  v_pk_add_f32 v[96:97], v[96:97], v[104:105]
  v_pk_add_f32 v[98:99], v[98:99], v[106:107]
  v_pk_add_f32 v[100:101], v[100:101], v[108:109]
  v_pk_add_f32 v[102:103], v[102:103], v[110:111]
  s_add_u32 m0, s61, 4096
  s_add_u32 s57, s60, 65536
  buffer_load_dwordx4 v244, s[36:39], s57 offen offset:0 lds
  buffer_load_dwordx4 v245, s[36:39], s57 offen offset:1024 lds
  buffer_load_dwordx4 v246, s[36:39], s57 offen offset:2048 lds
  buffer_load_dwordx4 v247, s[36:39], s57 offen offset:3072 lds
  v_add_f32 v160, v160, v161
  v_add_f32 v162, v162, v163
  v_add_f32 v160, v160, v162
  v_mov_b32 v161, v160
  s_nop 1
  v_permlane32_swap_b32 v160, v161
  s_nop 1
  v_add_f32 v160, v160, v161
  v_mov_b32 v161, v160
  s_nop 1
  v_permlane16_swap_b32 v160, v161
  s_nop 1
  v_add_f32 v160, v160, v161
  s_waitcnt vmcnt(21)
  v_lshlrev_b32 v104, 16, v40
  v_and_b32 v105, 0xffff0000, v40
  v_lshlrev_b32 v106, 16, v41
  v_and_b32 v107, 0xffff0000, v41
  v_lshlrev_b32 v108, 16, v42
  v_and_b32 v109, 0xffff0000, v42
  v_lshlrev_b32 v110, 16, v43
  v_and_b32 v111, 0xffff0000, v43
  v_pk_add_f32 v[96:97], v[96:97], v[104:105]
  v_pk_add_f32 v[98:99], v[98:99], v[106:107]
  v_pk_add_f32 v[100:101], v[100:101], v[108:109]
  v_pk_add_f32 v[102:103], v[102:103], v[110:111]
  s_add_u32 m0, s61, 8192
  s_add_u32 s57, s60, 131072
  buffer_load_dwordx4 v244, s[36:39], s57 offen offset:0 lds
  buffer_load_dwordx4 v245, s[36:39], s57 offen offset:1024 lds
  buffer_load_dwordx4 v246, s[36:39], s57 offen offset:2048 lds
  buffer_load_dwordx4 v247, s[36:39], s57 offen offset:3072 lds
  s_waitcnt vmcnt(24)
  v_lshlrev_b32 v104, 16, v44
  v_and_b32 v105, 0xffff0000, v44
  v_lshlrev_b32 v106, 16, v45
  v_and_b32 v107, 0xffff0000, v45
  v_lshlrev_b32 v108, 16, v46
  v_and_b32 v109, 0xffff0000, v46
  v_lshlrev_b32 v110, 16, v47
  v_and_b32 v111, 0xffff0000, v47
  v_pk_add_f32 v[96:97], v[96:97], v[104:105]
  v_pk_add_f32 v[98:99], v[98:99], v[106:107]
  v_pk_add_f32 v[100:101], v[100:101], v[108:109]
  v_pk_add_f32 v[102:103], v[102:103], v[110:111]
  s_add_u32 m0, s61, 12288
  s_add_u32 s57, s60, 196608
  buffer_load_dwordx4 v244, s[36:39], s57 offen offset:0 lds
  buffer_load_dwordx4 v245, s[36:39], s57 offen offset:1024 lds
  buffer_load_dwordx4 v246, s[36:39], s57 offen offset:2048 lds
  buffer_load_dwordx4 v247, s[36:39], s57 offen offset:3072 lds
  s_waitcnt vmcnt(27)
  v_lshlrev_b32 v104, 16, v48
  v_and_b32 v105, 0xffff0000, v48
  v_lshlrev_b32 v106, 16, v49
  v_and_b32 v107, 0xffff0000, v49
  v_lshlrev_b32 v108, 16, v50
  v_and_b32 v109, 0xffff0000, v50
  v_lshlrev_b32 v110, 16, v51
  v_and_b32 v111, 0xffff0000, v51
  v_pk_add_f32 v[96:97], v[96:97], v[104:105]
  v_pk_add_f32 v[98:99], v[98:99], v[106:107]
  v_pk_add_f32 v[100:101], v[100:101], v[108:109]
  v_pk_add_f32 v[102:103], v[102:103], v[110:111]
  s_waitcnt vmcnt(26)
  v_lshlrev_b32 v104, 16, v52
  v_and_b32 v105, 0xffff0000, v52
  v_lshlrev_b32 v106, 16, v53
  v_and_b32 v107, 0xffff0000, v53
  v_lshlrev_b32 v108, 16, v54
  v_and_b32 v109, 0xffff0000, v54
  v_lshlrev_b32 v110, 16, v55
  v_and_b32 v111, 0xffff0000, v55
  v_pk_add_f32 v[96:97], v[96:97], v[104:105]
  v_pk_add_f32 v[98:99], v[98:99], v[106:107]
  v_pk_add_f32 v[100:101], v[100:101], v[108:109]
  v_pk_add_f32 v[102:103], v[102:103], v[110:111]
  s_waitcnt vmcnt(25)
  v_lshlrev_b32 v104, 16, v56
  v_and_b32 v105, 0xffff0000, v56
  v_lshlrev_b32 v106, 16, v57
  v_and_b32 v107, 0xffff0000, v57
  v_lshlrev_b32 v108, 16, v58
  v_and_b32 v109, 0xffff0000, v58
  v_lshlrev_b32 v110, 16, v59
  v_and_b32 v111, 0xffff0000, v59
  v_pk_add_f32 v[96:97], v[96:97], v[104:105]
  v_pk_add_f32 v[98:99], v[98:99], v[106:107]
  v_pk_add_f32 v[100:101], v[100:101], v[108:109]
  v_pk_add_f32 v[102:103], v[102:103], v[110:111]
  s_waitcnt vmcnt(24)
  v_lshlrev_b32 v104, 16, v60
  v_and_b32 v105, 0xffff0000, v60
  v_lshlrev_b32 v106, 16, v61
  v_and_b32 v107, 0xffff0000, v61
  v_lshlrev_b32 v108, 16, v62
  v_and_b32 v109, 0xffff0000, v62
  v_lshlrev_b32 v110, 16, v63
  v_and_b32 v111, 0xffff0000, v63
  v_pk_add_f32 v[96:97], v[96:97], v[104:105]
  v_pk_add_f32 v[98:99], v[98:99], v[106:107]
  v_pk_add_f32 v[100:101], v[100:101], v[108:109]
  v_pk_add_f32 v[102:103], v[102:103], v[110:111]
  s_waitcnt vmcnt(23)
  v_lshlrev_b32 v104, 16, v64
  v_and_b32 v105, 0xffff0000, v64
  v_lshlrev_b32 v106, 16, v65
  v_and_b32 v107, 0xffff0000, v65
  v_lshlrev_b32 v108, 16, v66
  v_and_b32 v109, 0xffff0000, v66
  v_lshlrev_b32 v110, 16, v67
  v_and_b32 v111, 0xffff0000, v67
  v_pk_add_f32 v[96:97], v[96:97], v[104:105]
  v_pk_add_f32 v[98:99], v[98:99], v[106:107]
  v_pk_add_f32 v[100:101], v[100:101], v[108:109]
  v_pk_add_f32 v[102:103], v[102:103], v[110:111]
  s_waitcnt vmcnt(22)
  v_lshlrev_b32 v104, 16, v68
  v_and_b32 v105, 0xffff0000, v68
  v_lshlrev_b32 v106, 16, v69
  v_and_b32 v107, 0xffff0000, v69
  v_lshlrev_b32 v108, 16, v70
  v_and_b32 v109, 0xffff0000, v70
  v_lshlrev_b32 v110, 16, v71
  v_and_b32 v111, 0xffff0000, v71
  v_pk_add_f32 v[96:97], v[96:97], v[104:105]
  v_pk_add_f32 v[98:99], v[98:99], v[106:107]
  v_pk_add_f32 v[100:101], v[100:101], v[108:109]
  v_pk_add_f32 v[102:103], v[102:103], v[110:111]
  s_waitcnt vmcnt(21)
  v_lshlrev_b32 v104, 16, v72
  v_and_b32 v105, 0xffff0000, v72
  v_lshlrev_b32 v106, 16, v73
  v_and_b32 v107, 0xffff0000, v73
  v_lshlrev_b32 v108, 16, v74
  v_and_b32 v109, 0xffff0000, v74
  v_lshlrev_b32 v110, 16, v75
  v_and_b32 v111, 0xffff0000, v75
  v_pk_add_f32 v[96:97], v[96:97], v[104:105]
  v_pk_add_f32 v[98:99], v[98:99], v[106:107]
  v_pk_add_f32 v[100:101], v[100:101], v[108:109]
  v_pk_add_f32 v[102:103], v[102:103], v[110:111]
  s_waitcnt vmcnt(20)
  v_lshlrev_b32 v104, 16, v76
  v_and_b32 v105, 0xffff0000, v76
  v_lshlrev_b32 v106, 16, v77
  v_and_b32 v107, 0xffff0000, v77
  v_lshlrev_b32 v108, 16, v78
  v_and_b32 v109, 0xffff0000, v78
  v_lshlrev_b32 v110, 16, v79
  v_and_b32 v111, 0xffff0000, v79
  v_pk_add_f32 v[96:97], v[96:97], v[104:105]
  v_pk_add_f32 v[98:99], v[98:99], v[106:107]
  v_pk_add_f32 v[100:101], v[100:101], v[108:109]
  v_pk_add_f32 v[102:103], v[102:103], v[110:111]
  s_waitcnt vmcnt(19)
  v_lshlrev_b32 v104, 16, v80
  v_and_b32 v105, 0xffff0000, v80
  v_lshlrev_b32 v106, 16, v81
  v_and_b32 v107, 0xffff0000, v81
  v_lshlrev_b32 v108, 16, v82
  v_and_b32 v109, 0xffff0000, v82
  v_lshlrev_b32 v110, 16, v83
  v_and_b32 v111, 0xffff0000, v83
  v_pk_add_f32 v[96:97], v[96:97], v[104:105]
  v_pk_add_f32 v[98:99], v[98:99], v[106:107]
  v_pk_add_f32 v[100:101], v[100:101], v[108:109]
  v_pk_add_f32 v[102:103], v[102:103], v[110:111]
  s_waitcnt vmcnt(18)
  v_lshlrev_b32 v104, 16, v84
  v_and_b32 v105, 0xffff0000, v84
  v_lshlrev_b32 v106, 16, v85
  v_and_b32 v107, 0xffff0000, v85
  v_lshlrev_b32 v108, 16, v86
  v_and_b32 v109, 0xffff0000, v86
  v_lshlrev_b32 v110, 16, v87
  v_and_b32 v111, 0xffff0000, v87
  v_pk_add_f32 v[96:97], v[96:97], v[104:105]
  v_pk_add_f32 v[98:99], v[98:99], v[106:107]
  v_pk_add_f32 v[100:101], v[100:101], v[108:109]
  v_pk_add_f32 v[102:103], v[102:103], v[110:111]
  s_waitcnt vmcnt(17)
  v_lshlrev_b32 v104, 16, v88
  v_and_b32 v105, 0xffff0000, v88
  v_lshlrev_b32 v106, 16, v89
  v_and_b32 v107, 0xffff0000, v89
  v_lshlrev_b32 v108, 16, v90
  v_and_b32 v109, 0xffff0000, v90
  v_lshlrev_b32 v110, 16, v91
  v_and_b32 v111, 0xffff0000, v91
  v_pk_add_f32 v[96:97], v[96:97], v[104:105]
  v_pk_add_f32 v[98:99], v[98:99], v[106:107]
  v_pk_add_f32 v[100:101], v[100:101], v[108:109]
  v_pk_add_f32 v[102:103], v[102:103], v[110:111]
  s_waitcnt vmcnt(16)
  v_lshlrev_b32 v104, 16, v92
  v_and_b32 v105, 0xffff0000, v92
  v_lshlrev_b32 v106, 16, v93
  v_and_b32 v107, 0xffff0000, v93
  v_lshlrev_b32 v108, 16, v94
  v_and_b32 v109, 0xffff0000, v94
  v_lshlrev_b32 v110, 16, v95
  v_and_b32 v111, 0xffff0000, v95
  v_pk_add_f32 v[96:97], v[96:97], v[104:105]
  v_pk_add_f32 v[98:99], v[98:99], v[106:107]
  v_pk_add_f32 v[100:101], v[100:101], v[108:109]
  v_pk_add_f32 v[102:103], v[102:103], v[110:111]
  v_cvt_pk_bf16_f32 v180, v96, v97
  v_cvt_pk_bf16_f32 v181, v98, v99
  v_cvt_pk_bf16_f32 v182, v100, v101
  v_cvt_pk_bf16_f32 v183, v102, v103
  v_cvt_pk_bf16_f32 v160, v160, v160
  s_lshl_b32 s56, s69, 10
  s_add_u32 s56, s56, 156160
  v_add_u32 v7, s56, v4
  ds_write_b128 v7, v[180:183]
  s_lshl_b32 s56, s69, 5
  s_add_u32 s56, s56, 160256
  v_lshlrev_b32 v8, 1, v250
  v_add_u32 v8, s56, v8
  s_mov_b64 exec, 0xffff
  ds_write_b16 v8, v160
  s_mov_b64 exec, 1
  s_lshl_b32 s56, s69, 2
  s_add_u32 s56, s56, 160512
  v_mov_b32 v8, s56
  v_mov_b32 v9, s51
  s_waitcnt lgkmcnt(0)
  ds_write_b32 v8, v9
  s_mov_b64 exec, -1
  v_mov_b32 v8, 160512
  v_and_b32 v9, 3, v250
  v_lshl_add_u32 v8, v9, 2, v8
  s_mov_b32 s63, 160000
L_hsync:
  ds_read_b32 v9, v8
  s_waitcnt lgkmcnt(0)
  v_cmp_ne_u32 vcc, s51, v9
  s_cbranch_vccz L_hsyncd
  s_sub_u32 s63, s63, 1
  s_cbranch_scc0 L_hsync
L_hsyncd:
  s_lshl_b32 s56, s53, 11
  s_add_u32 s56, s56, 156160
  v_add_u32 v7, s56, v4
  ds_read_b128 v[184:187], v7
  ds_read_b128 v[188:191], v7 offset:1024
  s_lshl_b32 s56, s53, 6
  s_add_u32 s56, s56, 160256
  v_lshrrev_b32 v8, 5, v250
  v_lshlrev_b32 v8, 4, v8
  v_add_u32 v8, s56, v8
  ds_read_b128 v[192:195], v8
  ds_read_b128 v[196:199], v8 offset:32
  s_waitcnt lgkmcnt(0)
  v_mfma_f32_32x32x16_bf16 v[48:63], v[184:187], v[200:203], 0
  v_mfma_f32_32x32x16_bf16 v[80:95], v[192:195], v[200:203], 0
  v_mfma_f32_32x32x16_bf16 v[48:63], v[188:191], v[204:207], v[48:63]
  v_mfma_f32_32x32x16_bf16 v[80:95], v[196:199], v[204:207], v[80:95]
  v_mfma_f32_32x32x16_bf16 v[64:79], v[184:187], v[208:211], 0
  v_mfma_f32_32x32x16_bf16 v[96:111], v[192:195], v[208:211], 0
  v_mfma_f32_32x32x16_bf16 v[64:79], v[188:191], v[212:215], v[64:79]
  v_mfma_f32_32x32x16_bf16 v[96:111], v[196:199], v[212:215], v[96:111]
  s_lshl_b32 s58, s48, 18
  s_lshl_b32 s56, s49, 1
  s_add_u32 s56, s56, s53
  s_lshl_b32 s56, s56, 13
  s_add_u32 s58, s58, s56
  s_lshl_b32 s56, s52, 10
  s_add_u32 s58, s58, s56
  s_add_u32 s58, s58, 8454144
  v_and_b32 v7, 31, v250
  v_lshlrev_b32 v7, 4, v7
  v_lshrrev_b32 v8, 5, v250
  v_lshl_add_u32 v7, v8, 11, v7
  s_mov_b32 s59, 897988541
  s_nop 7
  v_add_f32 v80, s59, v80
  v_add_f32 v96, s59, v96
  v_rcp_f32 v80, v80
  v_rcp_f32 v96, v96
  s_nop 1
  v_mul_f32 v48, v48, v80
  v_mul_f32 v49, v49, v80
  v_cvt_pk_bf16_f32 v112, v48, v49
  v_mul_f32 v50, v50, v80
  v_mul_f32 v51, v51, v80
  v_cvt_pk_bf16_f32 v113, v50, v51
  v_mul_f32 v52, v52, v80
  v_mul_f32 v53, v53, v80
  v_cvt_pk_bf16_f32 v114, v52, v53
  v_mul_f32 v54, v54, v80
  v_mul_f32 v55, v55, v80
  v_cvt_pk_bf16_f32 v115, v54, v55
  v_mul_f32 v56, v56, v80
  v_mul_f32 v57, v57, v80
  v_cvt_pk_bf16_f32 v116, v56, v57
  v_mul_f32 v58, v58, v80
  v_mul_f32 v59, v59, v80
  v_cvt_pk_bf16_f32 v117, v58, v59
  v_mul_f32 v60, v60, v80
  v_mul_f32 v61, v61, v80
  v_cvt_pk_bf16_f32 v118, v60, v61
  v_mul_f32 v62, v62, v80
  v_mul_f32 v63, v63, v80
  v_cvt_pk_bf16_f32 v119, v62, v63
  s_add_u32 s56, s58, 0
  buffer_store_dwordx4 v[112:115], v7, s[12:15], s56 offen sc1
  s_add_u32 s56, s58, 4096
  buffer_store_dwordx4 v[116:119], v7, s[12:15], s56 offen sc1
  v_mul_f32 v64, v64, v96
  v_mul_f32 v65, v65, v96
  v_cvt_pk_bf16_f32 v120, v64, v65
  v_mul_f32 v66, v66, v96
  v_mul_f32 v67, v67, v96
  v_cvt_pk_bf16_f32 v121, v66, v67
  v_mul_f32 v68, v68, v96
  v_mul_f32 v69, v69, v96
  v_cvt_pk_bf16_f32 v122, v68, v69
  v_mul_f32 v70, v70, v96
  v_mul_f32 v71, v71, v96
  v_cvt_pk_bf16_f32 v123, v70, v71
  v_mul_f32 v72, v72, v96
  v_mul_f32 v73, v73, v96
  v_cvt_pk_bf16_f32 v124, v72, v73
  v_mul_f32 v74, v74, v96
  v_mul_f32 v75, v75, v96
  v_cvt_pk_bf16_f32 v125, v74, v75
  v_mul_f32 v76, v76, v96
  v_mul_f32 v77, v77, v96
  v_cvt_pk_bf16_f32 v126, v76, v77
  v_mul_f32 v78, v78, v96
  v_mul_f32 v79, v79, v96
  v_cvt_pk_bf16_f32 v127, v78, v79
  s_add_u32 s56, s58, 512
  buffer_store_dwordx4 v[120:123], v7, s[12:15], s56 offen sc1
  s_add_u32 s56, s58, 4608
  buffer_store_dwordx4 v[124:127], v7, s[12:15], s56 offen sc1
  s_lshl_b32 s56, s48, 1
  s_add_u32 s56, s56, s52
  s_lshl_b32 s56, s56, 7
  s_lshl_b32 s57, s49, 3
  s_add_u32 s56, s56, s57
  s_lshl_b32 s57, s53, 2
  s_add_u32 s56, s56, s57
  s_add_u32 s60, s56, 12288
  s_lshl_b32 s59, s69, 7
  s_waitcnt vmcnt(0)
  v_mov_b32 v8, 0
  v_mov_b32 v9, s51
  s_mov_b64 exec, 1
  buffer_store_dword v9, v8, s[12:15], s60 offen sc1
  s_mov_b64 exec, -1
  s_lshl_b32 s62, s69, 2
  s_add_u32 s62, s62, 160624
  v_mov_b32 v8, s62
  v_mov_b32 v9, s51
  ds_write_b32 v8, v9
  v_and_b32 v8, 7, v250
  v_lshlrev_b32 v8, 2, v8
  v_add_u32 v8, 160560, v8
  s_mov_b32 s63, 160000
cfh_12:
  ds_read_b32 v9, v8
  s_waitcnt lgkmcnt(0)
  v_cmp_ne_u32 vcc, s51, v9
  s_cbranch_vccz cfhd_13
  s_sub_u32 s63, s63, 1
  s_cbranch_scc0 cfh_12
cfhd_13:
  s_lshl_b32 s59, s69, 7
  s_add_u32 s59, s59, 512
  s_lshl_b32 s56, s59, 7
  s_lshl_b32 s57, s59, 11
  s_mov_b32 s58, 4
wo23h_14:
  s_mov_b32 m0, s56
  s_add_u32 s56, s56, 4096
  buffer_load_dwordx4 v244, s[36:39], s57 offen offset:0 lds
  buffer_load_dwordx4 v245, s[36:39], s57 offen offset:1024 lds
  buffer_load_dwordx4 v246, s[36:39], s57 offen offset:2048 lds
  buffer_load_dwordx4 v247, s[36:39], s57 offen offset:3072 lds
  s_add_u32 s57, s57, 65536
  s_sub_u32 s58, s58, 1
  s_cmp_lg_u32 s58, 0
  s_cbranch_scc1 wo23h_14
  v_and_b32 v2, 7, v250
  v_lshrrev_b32 v3, 3, v250
  s_lshl_b32 s56, s69, 3
  v_add_u32 v3, s56, v3
  v_lshlrev_b32 v3, 2, v3
  s_lshl_b32 s56, s48, 7
  v_add_u32 v3, s56, v3
  v_lshlrev_b32 v4, 3, v2
  s_lshl_b32 s56, s49, 6
  v_add_u32 v4, s56, v4
  v_lshlrev_b32 v5, 12, v4
  v_lshl_add_u32 v5, v3, 1, v5
  v_lshlrev_b32 v6, 11, v3
  v_lshl_add_u32 v6, v4, 1, v6
  v_lshlrev_b32 v7, 12, v3
  v_lshl_add_u32 v7, v4, 1, v7
  s_mov_b32 s57, 4096
  buffer_load_dwordx4 v[64:67], v6, s[44:47], 0 offen offset:0
  buffer_load_dwordx4 v[68:71], v6, s[44:47], 0 offen offset:2048
  buffer_load_dwordx4 v[72:75], v6, s[44:47], s57 offen offset:0
  buffer_load_dwordx4 v[76:79], v6, s[44:47], s57 offen offset:2048
  s_waitcnt vmcnt(4)
  s_lshl_b32 s62, s69, 2
  s_add_u32 s62, s62, 160592
  v_mov_b32 v8, s62
  v_mov_b32 v9, s51
  ds_write_b32 v8, v9
  v_lshlrev_b32 v2, 2, v250
  s_lshl_b32 s57, s49, 8
  s_add_u32 s57, s57, 16384
  s_setprio 0
  s_mov_b32 s63, 20000
pf4_15:
  buffer_load_dword v8, v2, s[12:15], s57 offen sc1
  s_waitcnt vmcnt(0)
  v_cmp_ne_u32 vcc, s51, v8
  s_cbranch_vccz pf4d_16
  s_sub_u32 s63, s63, 1
  s_cbranch_scc1 pf4d_16
  s_sleep 1
  s_branch pf4_15
pf4d_16:
  s_mov_b32 s56, 4259840
  buffer_load_dwordx2 v[32:33], v5, s[12:15], s56 offen sc1
  s_mov_b32 s56, 4263936
  buffer_load_dwordx2 v[34:35], v5, s[12:15], s56 offen sc1
  s_mov_b32 s56, 4268032
  buffer_load_dwordx2 v[36:37], v5, s[12:15], s56 offen sc1
  s_mov_b32 s56, 4272128
  buffer_load_dwordx2 v[38:39], v5, s[12:15], s56 offen sc1
  s_mov_b32 s56, 4276224
  buffer_load_dwordx2 v[40:41], v5, s[12:15], s56 offen sc1
  s_mov_b32 s56, 4280320
  buffer_load_dwordx2 v[42:43], v5, s[12:15], s56 offen sc1
  s_mov_b32 s56, 4284416
  buffer_load_dwordx2 v[44:45], v5, s[12:15], s56 offen sc1
  s_mov_b32 s56, 4288512
  buffer_load_dwordx2 v[46:47], v5, s[12:15], s56 offen sc1
  s_waitcnt vmcnt(0)
  v_lshlrev_b32 v96, 16, v64
  v_and_b32 v97, 0xffff0000, v64
  v_lshlrev_b32 v98, 16, v32
  v_lshlrev_b32 v99, 16, v34
  v_pk_mul_f32 v[96:97], v[96:97], v[98:99]
  v_cvt_pk_bf16_f32 v112, v96, v97
  v_lshlrev_b32 v100, 16, v65
  v_and_b32 v101, 0xffff0000, v65
  v_lshlrev_b32 v102, 16, v36
  v_lshlrev_b32 v103, 16, v38
  v_pk_mul_f32 v[100:101], v[100:101], v[102:103]
  v_cvt_pk_bf16_f32 v113, v100, v101
  v_lshlrev_b32 v96, 16, v66
  v_and_b32 v97, 0xffff0000, v66
  v_lshlrev_b32 v98, 16, v40
  v_lshlrev_b32 v99, 16, v42
  v_pk_mul_f32 v[96:97], v[96:97], v[98:99]
  v_cvt_pk_bf16_f32 v114, v96, v97
  v_lshlrev_b32 v100, 16, v67
  v_and_b32 v101, 0xffff0000, v67
  v_lshlrev_b32 v102, 16, v44
  v_lshlrev_b32 v103, 16, v46
  v_pk_mul_f32 v[100:101], v[100:101], v[102:103]
  v_cvt_pk_bf16_f32 v115, v100, v101
  s_mov_b32 s56, 0
  buffer_store_dwordx4 v[112:115], v7, s[40:43], s56 offen nt
  v_lshlrev_b32 v96, 16, v68
  v_and_b32 v97, 0xffff0000, v68
  v_and_b32 v98, 0xffff0000, v32
  v_and_b32 v99, 0xffff0000, v34
  v_pk_mul_f32 v[96:97], v[96:97], v[98:99]
  v_cvt_pk_bf16_f32 v116, v96, v97
  v_lshlrev_b32 v100, 16, v69
  v_and_b32 v101, 0xffff0000, v69
  v_and_b32 v102, 0xffff0000, v36
  v_and_b32 v103, 0xffff0000, v38
  v_pk_mul_f32 v[100:101], v[100:101], v[102:103]
  v_cvt_pk_bf16_f32 v117, v100, v101
  v_lshlrev_b32 v96, 16, v70
  v_and_b32 v97, 0xffff0000, v70
  v_and_b32 v98, 0xffff0000, v40
  v_and_b32 v99, 0xffff0000, v42
  v_pk_mul_f32 v[96:97], v[96:97], v[98:99]
  v_cvt_pk_bf16_f32 v118, v96, v97
  v_lshlrev_b32 v100, 16, v71
  v_and_b32 v101, 0xffff0000, v71
  v_and_b32 v102, 0xffff0000, v44
  v_and_b32 v103, 0xffff0000, v46
  v_pk_mul_f32 v[100:101], v[100:101], v[102:103]
  v_cvt_pk_bf16_f32 v119, v100, v101
  s_mov_b32 s56, 4096
  buffer_store_dwordx4 v[116:119], v7, s[40:43], s56 offen nt
  v_lshlrev_b32 v96, 16, v72
  v_and_b32 v97, 0xffff0000, v72
  v_lshlrev_b32 v98, 16, v33
  v_lshlrev_b32 v99, 16, v35
  v_pk_mul_f32 v[96:97], v[96:97], v[98:99]
  v_cvt_pk_bf16_f32 v120, v96, v97
  v_lshlrev_b32 v100, 16, v73
  v_and_b32 v101, 0xffff0000, v73
  v_lshlrev_b32 v102, 16, v37
  v_lshlrev_b32 v103, 16, v39
  v_pk_mul_f32 v[100:101], v[100:101], v[102:103]
  v_cvt_pk_bf16_f32 v121, v100, v101
  v_lshlrev_b32 v96, 16, v74
  v_and_b32 v97, 0xffff0000, v74
  v_lshlrev_b32 v98, 16, v41
  v_lshlrev_b32 v99, 16, v43
  v_pk_mul_f32 v[96:97], v[96:97], v[98:99]
  v_cvt_pk_bf16_f32 v122, v96, v97
  v_lshlrev_b32 v100, 16, v75
  v_and_b32 v101, 0xffff0000, v75
  v_lshlrev_b32 v102, 16, v45
  v_lshlrev_b32 v103, 16, v47
  v_pk_mul_f32 v[100:101], v[100:101], v[102:103]
  v_cvt_pk_bf16_f32 v123, v100, v101
  s_mov_b32 s56, 8192
  buffer_store_dwordx4 v[120:123], v7, s[40:43], s56 offen nt
  v_lshlrev_b32 v96, 16, v76
  v_and_b32 v97, 0xffff0000, v76
  v_and_b32 v98, 0xffff0000, v33
  v_and_b32 v99, 0xffff0000, v35
  v_pk_mul_f32 v[96:97], v[96:97], v[98:99]
  v_cvt_pk_bf16_f32 v124, v96, v97
  v_lshlrev_b32 v100, 16, v77
  v_and_b32 v101, 0xffff0000, v77
  v_and_b32 v102, 0xffff0000, v37
  v_and_b32 v103, 0xffff0000, v39
  v_pk_mul_f32 v[100:101], v[100:101], v[102:103]
  v_cvt_pk_bf16_f32 v125, v100, v101
  v_lshlrev_b32 v96, 16, v78
  v_and_b32 v97, 0xffff0000, v78
  v_and_b32 v98, 0xffff0000, v41
  v_and_b32 v99, 0xffff0000, v43
  v_pk_mul_f32 v[96:97], v[96:97], v[98:99]
  v_cvt_pk_bf16_f32 v126, v96, v97
  v_lshlrev_b32 v100, 16, v79
  v_and_b32 v101, 0xffff0000, v79
  v_and_b32 v102, 0xffff0000, v45
  v_and_b32 v103, 0xffff0000, v47
  v_pk_mul_f32 v[100:101], v[100:101], v[102:103]
  v_cvt_pk_bf16_f32 v127, v100, v101
  s_mov_b32 s56, 12288
  buffer_store_dwordx4 v[124:127], v7, s[40:43], s56 offen nt
  s_waitcnt vmcnt(0)
L_end:
  s_endpgm
.section .rodata,"a"
.p2align 6
.amdhsa_kernel concat_heads__ssm_conv_h3__linear_attn_block__prompt_kernel
  .amdhsa_next_free_vgpr 256
  .amdhsa_next_free_sgpr 102
  .amdhsa_accum_offset 256
  .amdhsa_group_segment_fixed_size 0
  .amdhsa_kernarg_size 96
  .amdhsa_user_sgpr_count 2
  .amdhsa_user_sgpr_kernarg_segment_ptr 1
  .amdhsa_system_sgpr_workgroup_id_x 1
.end_amdhsa_kernel
.text
```
